```python
import torch

def _softmax(x, axis=-1):
    return torch.softmax(x, dim=axis)
def _gelu(x):
    return torch.nn.functional.gelu(x, approximate="tanh")
def _silu(x):
    return torch.nn.functional.silu(x)
def _sigmoid(x):
    return torch.sigmoid(x)
def _layernorm(x, axis=-1, eps=1e-5):
    m = x.mean(dim=axis, keepdim=True)
    v = x.var(dim=axis, keepdim=True, unbiased=False)
    return (x - m) / torch.sqrt(v + eps)
def _scatter_add(tgt, idx, src, axis=0):
    return tgt.clone().index_add_(axis, idx, src)
def _segment_sum(src, seg, n):
    out = torch.zeros((n,) + src.shape[1:], dtype=src.dtype)
    return out.index_add_(0, seg, src)
def _pad(x, pw):
    flat = tuple(v for pair in reversed(pw) for v in pair)
    return torch.nn.functional.pad(x, flat)

kernel_name = 'standalone__dense_activation_gelu__prompt'

def setup_inputs():

    _w = (lambda a: (lambda t: t.to(torch.bfloat16) if t.is_floating_point() else t)(torch.as_tensor(a)))
    B, S, D, F = 1, 2048, 1024, 3584
    return {
        "x": _w((lambda *s: torch.randn(*s, dtype=torch.bfloat16) * 0.05)(B, S, D)),
        "w1": _w((lambda *s: torch.randn(*s, dtype=torch.bfloat16) * 3.2)(D, F) * (D ** -0.5)),
        "b1": _w((lambda *s: torch.randn(*s, dtype=torch.bfloat16) * 3.2)(F) * 0.01),
        "w2": _w((lambda *s: torch.randn(*s, dtype=torch.bfloat16) * 0.05)(F, D) * (F ** -0.5)),
        "b2": _w((lambda *s: torch.randn(*s, dtype=torch.bfloat16) * 0.1)(D) * 0.01),
    }

def reference(x, w1, b1, w2, b2):
    h = torch.einsum("bsd,df->bsf", x, w1) + b1
    h = _gelu(h)
    return torch.einsum("bsf,fd->bsd", h, w2) + b2
```

```asm
; @launch kernel=mlp_kernel grid=(256,1,1) block=(512,1,1) lds=163840
.amdgcn_target "amdgcn-amd-amdhsa--gfx950"
.text
.globl mlp_kernel
.p2align 8
.type mlp_kernel,@function
mlp_kernel:
    s_cmp_ge_u32 s2, 256
    s_cbranch_scc1 K_end
    s_load_dwordx16 s[64:79], s[0:1], 0
    v_lshrrev_b32 v1, 6, v0
    v_and_b32 v240, 63, v0
    s_and_b32 s21, s2, 7
    v_readfirstlane_b32 s20, v1
    s_lshr_b32 s22, s2, 3
    s_and_b32 s23, s21, 1
    s_lshl_b32 s23, s23, 3
    s_and_b32 s24, s22, 7
    s_add_u32 s23, s23, s24
    s_lshr_b32 s24, s21, 1
    s_lshl_b32 s24, s24, 2
    s_lshr_b32 s25, s22, 3
    s_add_u32 s24, s24, s25
    s_and_b32 s56, s21, 1
    s_bfe_u32 s54, s21, 0x10001
    s_lshl_b32 s54, s54, 3
    s_and_b32 s55, s22, 7
    s_add_u32 s54, s54, s55
    s_lshr_b32 s55, s21, 2
    s_lshl_b32 s55, s55, 2
    s_add_u32 s55, s55, s25
    s_lshr_b32 s56, s21, 2
    s_xor_b32 s56, s56, 1
    s_mov_b32 s54, s23
    s_and_b32 s55, s24, 7
    s_cmp_ge_u32 s20, 4
    s_cbranch_scc0 G1_compute
    s_sub_u32 s20, s20, 4
    v_lshrrev_b32 v3, 3, v240
    v_and_b32 v4, 7, v240
    v_lshrrev_b32 v5, 4, v240
    v_xor_b32 v6, v4, v5
    v_xor_b32 v7, 4, v6
    v_lshlrev_b32 v6, 4, v6
    v_lshlrev_b32 v7, 4, v7
    s_lshl_b32 s26, s23, 7
    s_lshl_b32 s27, s20, 5
    s_add_u32 s26, s26, s27
    v_add_u32 v3, s26, v3
    v_lshlrev_b32 v3, 11, v3
    v_add_u32 v10, 0, v3
    v_add_u32 v10, v10, v6
    v_add_u32 v11, 15360, v3
    v_add_u32 v11, v11, v7
    v_add_u32 v12, 30720, v3
    v_add_u32 v12, v12, v6
    v_add_u32 v13, 46080, v3
    v_add_u32 v13, v13, v7
    v_lshrrev_b32 v3, 5, v240
    v_and_b32 v4, 31, v240
    s_mul_i32 s26, s24, 448
    s_and_b32 s26, s26, 0xffffff80
    s_mul_i32 s27, s20, 114688
    s_add_u32 s26, s26, s27
    v_mul_u32_u24 v5, 7168, v3
    v_add_u32 v5, s26, v5
    v_lshlrev_b32 v6, 1, v3
    v_xor_b32 v6, v6, v4
    v_xor_b32 v7, 0, v6
    v_lshlrev_b32 v7, 4, v7
    v_add_u32 v14, 0, v5
    v_add_u32 v14, v14, v7
    v_xor_b32 v7, 4, v6
    v_lshlrev_b32 v7, 4, v7
    v_add_u32 v15, 13312, v5
    v_add_u32 v15, v15, v7
    v_xor_b32 v7, 0, v6
    v_lshlrev_b32 v7, 4, v7
    v_add_u32 v16, 26624, v5
    v_add_u32 v16, v16, v7
    v_xor_b32 v7, 4, v6
    v_lshlrev_b32 v7, 4, v7
    v_add_u32 v17, 39936, v5
    v_add_u32 v17, v17, v7
    v_xor_b32 v7, 8, v6
    v_lshlrev_b32 v7, 4, v7
    v_add_u32 v18, 57344, v5
    v_add_u32 v18, v18, v7
    v_xor_b32 v7, 12, v6
    v_lshlrev_b32 v7, 4, v7
    v_add_u32 v19, 70656, v5
    v_add_u32 v19, v19, v7
    v_xor_b32 v7, 8, v6
    v_lshlrev_b32 v7, 4, v7
    v_add_u32 v20, 83968, v5
    v_add_u32 v20, v20, v7
    v_xor_b32 v7, 12, v6
    v_lshlrev_b32 v7, 4, v7
    v_add_u32 v21, 97280, v5
    v_add_u32 v21, v21, v7
    s_waitcnt lgkmcnt(0)
    s_mov_b32 s8, s64
    s_and_b32 s9, s65, 0xffff
    s_mov_b32 s10, 4194304
    s_mov_b32 s11, 0x20000
    s_mov_b32 s12, s66
    s_and_b32 s13, s67, 0xffff
    s_mov_b32 s14, 7340032
    s_mov_b32 s15, 0x20000
    s_lshl_b32 s30, s20, 12
    s_lshl_b32 s31, s20, 13
    s_add_u32 s31, s31, 16384
    s_mov_b32 s32, 0
    s_mov_b32 s33, 0
    s_add_u32 s26, s23, s24
    s_and_b32 s26, s26, 3
    s_mul_i32 s32, s26, 512
    s_mul_i32 s33, s26, 1835008
    s_mov_b32 s34, 0
    s_mov_b32 s40, s76
    s_and_b32 s41, s77, 0xffff
    s_mov_b32 s42, 256
    s_mov_b32 s43, 0x20000
    v_mov_b32 v28, 0
    s_or_b32 s26, s2, s20
    s_cmp_lg_u32 s26, 0
    s_cbranch_scc1 G1_notag
    s_memrealtime s[60:61]
    s_waitcnt lgkmcnt(0)
    s_or_b32 s60, s60, 1
    v_mov_b32 v24, s60
    v_mov_b32 v25, s61
    s_mov_b64 exec, 1
    buffer_store_dwordx2 v[24:25], v28, s[40:43], 0 offen sc0 sc1
    s_mov_b64 exec, -1
G1_notag:
    s_add_u32 m0, s30, s34
    s_add_u32 s36, s31, s34
    buffer_load_dwordx4 v10, s[8:11], s32 offen offset:0 lds
    buffer_load_dwordx4 v11, s[8:11], s32 offen offset:1024 lds
    buffer_load_dwordx4 v12, s[8:11], s32 offen offset:2048 lds
    buffer_load_dwordx4 v13, s[8:11], s32 offen offset:3072 lds
    s_mov_b32 m0, s36
    s_add_u32 s36, s36, 4096
    buffer_load_dwordx4 v14, s[12:15], s33 offen offset:0 lds
    buffer_load_dwordx4 v15, s[12:15], s33 offen offset:1024 lds
    buffer_load_dwordx4 v16, s[12:15], s33 offen offset:2048 lds
    buffer_load_dwordx4 v17, s[12:15], s33 offen offset:3072 lds
    s_mov_b32 m0, s36
    s_add_u32 s32, s32, 128
    buffer_load_dwordx4 v18, s[12:15], s33 offen offset:0 lds
    buffer_load_dwordx4 v19, s[12:15], s33 offen offset:1024 lds
    buffer_load_dwordx4 v20, s[12:15], s33 offen offset:2048 lds
    buffer_load_dwordx4 v21, s[12:15], s33 offen offset:3072 lds
    s_add_u32 s33, s33, 458752
    s_cmp_eq_u32 s32, 2048
    s_cselect_b32 s32, 0, s32
    s_cselect_b32 s33, 0, s33
    s_add_u32 s34, s34, 49152
    s_cmp_eq_u32 s34, 147456
    s_cselect_b32 s34, 0, s34
    s_add_u32 m0, s30, s34
    s_add_u32 s36, s31, s34
    buffer_load_dwordx4 v10, s[8:11], s32 offen offset:0 lds
    buffer_load_dwordx4 v11, s[8:11], s32 offen offset:1024 lds
    buffer_load_dwordx4 v12, s[8:11], s32 offen offset:2048 lds
    buffer_load_dwordx4 v13, s[8:11], s32 offen offset:3072 lds
    s_mov_b32 m0, s36
    s_add_u32 s36, s36, 4096
    buffer_load_dwordx4 v14, s[12:15], s33 offen offset:0 lds
    buffer_load_dwordx4 v15, s[12:15], s33 offen offset:1024 lds
    buffer_load_dwordx4 v16, s[12:15], s33 offen offset:2048 lds
    buffer_load_dwordx4 v17, s[12:15], s33 offen offset:3072 lds
    s_mov_b32 m0, s36
    s_add_u32 s32, s32, 128
    buffer_load_dwordx4 v18, s[12:15], s33 offen offset:0 lds
    buffer_load_dwordx4 v19, s[12:15], s33 offen offset:1024 lds
    buffer_load_dwordx4 v20, s[12:15], s33 offen offset:2048 lds
    buffer_load_dwordx4 v21, s[12:15], s33 offen offset:3072 lds
    s_add_u32 s33, s33, 458752
    s_cmp_eq_u32 s32, 2048
    s_cselect_b32 s32, 0, s32
    s_cselect_b32 s33, 0, s33
    s_add_u32 s34, s34, 49152
    s_cmp_eq_u32 s34, 147456
    s_cselect_b32 s34, 0, s34
    s_add_u32 m0, s30, s34
    s_add_u32 s36, s31, s34
    buffer_load_dwordx4 v10, s[8:11], s32 offen offset:0 lds
    buffer_load_dwordx4 v11, s[8:11], s32 offen offset:1024 lds
    buffer_load_dwordx4 v12, s[8:11], s32 offen offset:2048 lds
    buffer_load_dwordx4 v13, s[8:11], s32 offen offset:3072 lds
    s_mov_b32 m0, s36
    s_add_u32 s36, s36, 4096
    buffer_load_dwordx4 v14, s[12:15], s33 offen offset:0 lds
    buffer_load_dwordx4 v15, s[12:15], s33 offen offset:1024 lds
    buffer_load_dwordx4 v16, s[12:15], s33 offen offset:2048 lds
    buffer_load_dwordx4 v17, s[12:15], s33 offen offset:3072 lds
    s_mov_b32 m0, s36
    s_add_u32 s32, s32, 128
    buffer_load_dwordx4 v18, s[12:15], s33 offen offset:0 lds
    buffer_load_dwordx4 v19, s[12:15], s33 offen offset:1024 lds
    buffer_load_dwordx4 v20, s[12:15], s33 offen offset:2048 lds
    buffer_load_dwordx4 v21, s[12:15], s33 offen offset:3072 lds
    s_add_u32 s33, s33, 458752
    s_cmp_eq_u32 s32, 2048
    s_cselect_b32 s32, 0, s32
    s_cselect_b32 s33, 0, s33
    s_add_u32 s34, s34, 49152
    s_cmp_eq_u32 s34, 147456
    s_cselect_b32 s34, 0, s34
    s_waitcnt vmcnt(24)
    s_barrier
    s_mov_b32 s35, 0
    s_mov_b32 s44, s70
    s_and_b32 s45, s71, 0xffff
    s_mov_b32 s46, 7340032
    s_mov_b32 s47, 0x20000
    v_min_u32 v5, 55, v240
    s_lshl_b32 s26, s2, 2
    s_add_u32 s26, s26, s20
    s_mul_i32 s26, s26, 56
    v_add_u32 v5, s26, v5
    v_lshlrev_b32 v5, 7, v5
    s_lshl_b32 s26, s26, 7
    s_add_u32 s58, s70, s26
    s_addc_u32 s59, s71, 0
G1_lloop:
    s_waitcnt vmcnt(12)
    s_barrier
    s_add_u32 m0, s30, s34
    s_add_u32 s36, s31, s34
    buffer_load_dwordx4 v10, s[8:11], s32 offen offset:0 lds
    buffer_load_dwordx4 v11, s[8:11], s32 offen offset:1024 lds
    buffer_load_dwordx4 v12, s[8:11], s32 offen offset:2048 lds
    buffer_load_dwordx4 v13, s[8:11], s32 offen offset:3072 lds
    s_mov_b32 m0, s36
    s_add_u32 s36, s36, 4096
    buffer_load_dwordx4 v14, s[12:15], s33 offen offset:0 lds
    buffer_load_dwordx4 v15, s[12:15], s33 offen offset:1024 lds
    buffer_load_dwordx4 v16, s[12:15], s33 offen offset:2048 lds
    buffer_load_dwordx4 v17, s[12:15], s33 offen offset:3072 lds
    s_mov_b32 m0, s36
    s_add_u32 s32, s32, 128
    buffer_load_dwordx4 v18, s[12:15], s33 offen offset:0 lds
    buffer_load_dwordx4 v19, s[12:15], s33 offen offset:1024 lds
    buffer_load_dwordx4 v20, s[12:15], s33 offen offset:2048 lds
    buffer_load_dwordx4 v21, s[12:15], s33 offen offset:3072 lds
    s_add_u32 s33, s33, 458752
    s_cmp_eq_u32 s32, 2048
    s_cselect_b32 s32, 0, s32
    s_cselect_b32 s33, 0, s33
    s_add_u32 s34, s34, 49152
    s_cmp_eq_u32 s34, 147456
    s_cselect_b32 s34, 0, s34
    s_add_u32 s35, s35, 1
    s_cmp_lt_u32 s35, 13
    s_cbranch_scc1 G1_lloop
    s_getpc_b64 s[48:49]
CT_2:
    s_sub_u32 s48, s48, CT_2-mlp_kernel
    s_subb_u32 s49, s49, 0
    s_lshl_b32 s50, s20, 13
    v_lshlrev_b32 v31, 7, v240
    v_add_u32 v31, s50, v31
    v_min_u32 v31, K_last-mlp_kernel, v31
    global_load_dword v30, v31, s[48:49]
    buffer_load_dword v30, v5, s[44:47], 0 offen
    s_waitcnt vmcnt(14)
    s_barrier
    s_waitcnt vmcnt(2)
    s_barrier
    buffer_load_dwordx2 v[24:25], v28, s[40:43], 0 offen sc0 sc1
G2_loader:
    s_waitcnt lgkmcnt(0)
    s_mov_b32 s23, s54
    s_mov_b32 s24, s55
    s_mov_b32 s25, s56
    s_lshl_b32 s26, s23, 7
    s_mul_i32 s27, s25, 56
    s_add_u32 s26, s26, s27
    s_lshl_b32 s26, s26, 13
    s_lshl_b32 s30, s20, 12
    s_and_b32 s59, s20, 1
    s_lshr_b32 s57, s20, 1
    s_lshl_b32 s27, s59, 12
    s_add_u32 s26, s26, s27
    v_lshlrev_b32 v3, 4, v240
    v_add_u32 v10, s26, v3
    v_lshrrev_b32 v3, 4, v240
    v_and_b32 v4, 15, v240
    v_lshlrev_b32 v5, 1, v3
    v_xor_b32 v6, v5, v4
    v_xor_b32 v7, 8, v6
    v_lshlrev_b32 v6, 4, v6
    v_lshlrev_b32 v7, 4, v7
    s_mul_i32 s26, s25, 1792
    s_lshl_b32 s27, s59, 4
    s_add_u32 s26, s26, s27
    v_add_u32 v3, s26, v3
    v_lshlrev_b32 v3, 11, v3
    s_lshl_b32 s26, s24, 8
    v_add_u32 v3, s26, v3
    v_add_u32 v14, 0, v3
    v_add_u32 v14, v14, v6
    v_add_u32 v15, 7168, v3
    v_add_u32 v15, v15, v7
    v_add_u32 v16, 14336, v3
    v_add_u32 v16, v16, v6
    v_add_u32 v17, 21504, v3
    v_add_u32 v17, v17, v7
    s_mov_b32 s8, s78
    s_and_b32 s9, s79, 0xffff
    s_mov_b32 s10, 16777216
    s_mov_b32 s11, 0x20000
    s_mov_b32 s12, s70
    s_and_b32 s13, s71, 0xffff
    s_mov_b32 s14, 7340032
    s_mov_b32 s15, 0x20000
    s_add_u32 s44, s78, 34603008
    s_addc_u32 s45, s79, 0
    s_and_b32 s45, s45, 0xffff
    s_mov_b32 s46, 524288
    s_mov_b32 s47, 0x20000
    s_lshl_b32 s26, s23, 1
    s_add_u32 s26, s26, s25
    s_lshl_b32 s26, s26, 1
    s_add_u32 s26, s26, s59
    s_lshl_b32 s26, s26, 9
    v_lshlrev_b32 v4, 3, v4
    v_add_u32 v11, s26, v4
    s_add_u32 s31, s30, 16384
    s_mov_b32 s34, 0
    s_mul_i32 s58, s57, 7
    s_add_u32 s58, s58, 3
    s_lshl_b32 s33, s58, 16
    s_mul_i32 s27, s59, 4294942720
    s_add_u32 s27, s27, s33
    s_add_u32 s80, s27, 0
    s_add_u32 s81, s27, 8192
    s_add_u32 s82, s27, 16384
    s_add_u32 s83, s27, 24576
    s_lshl_b32 s58, s58, 13
    s_lshl_b32 s32, s57, 15
    s_lshl_b32 s33, s57, 18
    s_barrier
    s_add_u32 m0, s31, 0
    s_nop 0
    buffer_load_dwordx4 v14, s[12:15], s80 offen offset:0 lds
    buffer_load_dwordx4 v15, s[12:15], s81 offen offset:1024 lds
    buffer_load_dwordx4 v16, s[12:15], s82 offen offset:2048 lds
    buffer_load_dwordx4 v17, s[12:15], s83 offen offset:3072 lds
    s_add_u32 s80, s80, 917504
    s_add_u32 s81, s81, 917504
    s_add_u32 s82, s82, 917504
    s_add_u32 s83, s83, 917504
    s_add_u32 m0, s31, 32768
    s_nop 0
    buffer_load_dwordx4 v14, s[12:15], s80 offen offset:0 lds
    buffer_load_dwordx4 v15, s[12:15], s81 offen offset:1024 lds
    buffer_load_dwordx4 v16, s[12:15], s82 offen offset:2048 lds
    buffer_load_dwordx4 v17, s[12:15], s83 offen offset:3072 lds
    s_add_u32 s80, s80, 917504
    s_add_u32 s81, s81, 917504
    s_add_u32 s82, s82, 917504
    s_add_u32 s83, s83, 917504
    s_add_u32 m0, s31, 65536
    s_nop 0
    buffer_load_dwordx4 v14, s[12:15], s80 offen offset:0 lds
    buffer_load_dwordx4 v15, s[12:15], s81 offen offset:1024 lds
    buffer_load_dwordx4 v16, s[12:15], s82 offen offset:2048 lds
    buffer_load_dwordx4 v17, s[12:15], s83 offen offset:3072 lds
    s_add_u32 s80, s80, 917504
    s_add_u32 s81, s81, 917504
    s_add_u32 s82, s82, 917504
    s_add_u32 s83, s83, 917504
    s_mov_b32 s51, 0x40000
G2_ltag:
    s_waitcnt vmcnt(0)
    v_readfirstlane_b32 s62, v24
    v_readfirstlane_b32 s63, v25
    s_cmp_lg_u32 s62, 0
    s_cbranch_scc1 G2_ltok
    buffer_load_dwordx2 v[24:25], v28, s[40:43], 0 offen sc0 sc1
    s_sub_u32 s51, s51, 1
    s_cmp_lg_u32 s51, 0
    s_cbranch_scc1 G2_ltag
G2_ltok:
G2_pm_p:
    buffer_load_dwordx2 v[12:13], v11, s[44:47], 0 offen sc0 sc1
    s_waitcnt vmcnt(0)
    v_cmp_ne_u64 vcc, s[62:63], v[12:13]
    s_cbranch_vccz G2_pm_g
    s_sleep 1
    s_sub_u32 s51, s51, 1
    s_cmp_gt_i32 s51, 0
    s_cbranch_scc1 G2_pm_p
G2_pm_g:
    v_add_u32 v11, 128, v11
    s_add_u32 m0, s30, 0
    s_nop 0
    buffer_load_dwordx4 v10, s[8:11], s58 offen offset:0 sc1 lds
    buffer_load_dwordx4 v10, s[8:11], s58 offen offset:1024 sc1 lds
    buffer_load_dwordx4 v10, s[8:11], s58 offen offset:2048 sc1 lds
    buffer_load_dwordx4 v10, s[8:11], s58 offen offset:3072 sc1 lds
    s_add_u32 s58, s58, 114688
    s_add_u32 m0, s30, 32768
    s_nop 0
    buffer_load_dwordx4 v10, s[8:11], s58 offen offset:0 sc1 lds
    buffer_load_dwordx4 v10, s[8:11], s58 offen offset:1024 sc1 lds
    buffer_load_dwordx4 v10, s[8:11], s58 offen offset:2048 sc1 lds
    buffer_load_dwordx4 v10, s[8:11], s58 offen offset:3072 sc1 lds
    s_add_u32 s58, s58, 114688
    s_add_u32 m0, s30, 65536
    s_nop 0
    buffer_load_dwordx4 v10, s[8:11], s58 offen offset:0 sc1 lds
    buffer_load_dwordx4 v10, s[8:11], s58 offen offset:1024 sc1 lds
    buffer_load_dwordx4 v10, s[8:11], s58 offen offset:2048 sc1 lds
    buffer_load_dwordx4 v10, s[8:11], s58 offen offset:3072 sc1 lds
    s_add_u32 s58, s58, 114688
    s_add_u32 m0, s30, 98304
    s_nop 0
    buffer_load_dwordx4 v10, s[8:11], s58 offen offset:0 sc1 lds
    buffer_load_dwordx4 v10, s[8:11], s58 offen offset:1024 sc1 lds
    buffer_load_dwordx4 v10, s[8:11], s58 offen offset:2048 sc1 lds
    buffer_load_dwordx4 v10, s[8:11], s58 offen offset:3072 sc1 lds
    s_add_u32 m0, s31, 98304
    s_nop 0
    buffer_load_dwordx4 v14, s[12:15], s80 offen offset:0 lds
    buffer_load_dwordx4 v15, s[12:15], s81 offen offset:1024 lds
    buffer_load_dwordx4 v16, s[12:15], s82 offen offset:2048 lds
    buffer_load_dwordx4 v17, s[12:15], s83 offen offset:3072 lds
    s_add_u32 m0, s31, 131072
    s_nop 0
    buffer_load_dwordx4 v14, s[12:15], s33 offen offset:0 lds
    buffer_load_dwordx4 v15, s[12:15], s33 offen offset:1024 lds
    buffer_load_dwordx4 v16, s[12:15], s33 offen offset:2048 lds
    buffer_load_dwordx4 v17, s[12:15], s33 offen offset:3072 lds
G2_p0_p:
    buffer_load_dwordx2 v[12:13], v11, s[44:47], 0 offen sc0 sc1
    s_waitcnt vmcnt(0)
    v_cmp_ne_u64 vcc, s[62:63], v[12:13]
    s_cbranch_vccz G2_p0_g
    s_sleep 1
    s_sub_u32 s51, s51, 1
    s_cmp_gt_i32 s51, 0
    s_cbranch_scc1 G2_p0_p
G2_p0_g:
    v_add_u32 v11, 128, v11
    s_add_u32 m0, s30, 131072
    s_nop 0
    buffer_load_dwordx4 v10, s[8:11], s32 offen offset:0 sc1 lds
    buffer_load_dwordx4 v10, s[8:11], s32 offen offset:1024 sc1 lds
    buffer_load_dwordx4 v10, s[8:11], s32 offen offset:2048 sc1 lds
    buffer_load_dwordx4 v10, s[8:11], s32 offen offset:3072 sc1 lds
    s_add_u32 s32, s32, 57344
    s_cmp_ge_u32 s32, 458752
    s_cselect_b32 s36, 450560, 0
    s_sub_u32 s32, s32, s36
    s_lshl_b32 s33, s32, 3
    s_barrier
    s_barrier
    s_add_u32 m0, s31, s34
    s_nop 0
    buffer_load_dwordx4 v14, s[12:15], s33 offen offset:0 lds
    buffer_load_dwordx4 v15, s[12:15], s33 offen offset:1024 lds
    buffer_load_dwordx4 v16, s[12:15], s33 offen offset:2048 lds
    buffer_load_dwordx4 v17, s[12:15], s33 offen offset:3072 lds
    s_add_u32 m0, s30, s34
    s_nop 0
    buffer_load_dwordx4 v10, s[8:11], s32 offen offset:0 sc1 lds
    buffer_load_dwordx4 v10, s[8:11], s32 offen offset:1024 sc1 lds
    buffer_load_dwordx4 v10, s[8:11], s32 offen offset:2048 sc1 lds
    buffer_load_dwordx4 v10, s[8:11], s32 offen offset:3072 sc1 lds
    s_add_u32 s32, s32, 57344
    s_cmp_ge_u32 s32, 458752
    s_cselect_b32 s36, 450560, 0
    s_sub_u32 s32, s32, s36
    s_lshl_b32 s33, s32, 3
    s_add_u32 s34, s34, 32768
    s_cmp_eq_u32 s34, 163840
    s_cselect_b32 s34, 0, s34
    s_barrier
    s_add_u32 m0, s31, s34
    s_nop 0
    buffer_load_dwordx4 v14, s[12:15], s33 offen offset:0 lds
    buffer_load_dwordx4 v15, s[12:15], s33 offen offset:1024 lds
    buffer_load_dwordx4 v16, s[12:15], s33 offen offset:2048 lds
    buffer_load_dwordx4 v17, s[12:15], s33 offen offset:3072 lds
    s_add_u32 m0, s30, s34
    s_nop 0
    buffer_load_dwordx4 v10, s[8:11], s32 offen offset:0 sc1 lds
    buffer_load_dwordx4 v10, s[8:11], s32 offen offset:1024 sc1 lds
    buffer_load_dwordx4 v10, s[8:11], s32 offen offset:2048 sc1 lds
    buffer_load_dwordx4 v10, s[8:11], s32 offen offset:3072 sc1 lds
    s_add_u32 s32, s32, 57344
    s_cmp_ge_u32 s32, 458752
    s_cselect_b32 s36, 450560, 0
    s_sub_u32 s32, s32, s36
    s_lshl_b32 s33, s32, 3
    s_add_u32 s34, s34, 32768
    s_cmp_eq_u32 s34, 163840
    s_cselect_b32 s34, 0, s34
    s_barrier
    s_add_u32 m0, s31, s34
    s_nop 0
    buffer_load_dwordx4 v14, s[12:15], s33 offen offset:0 lds
    buffer_load_dwordx4 v15, s[12:15], s33 offen offset:1024 lds
    buffer_load_dwordx4 v16, s[12:15], s33 offen offset:2048 lds
    buffer_load_dwordx4 v17, s[12:15], s33 offen offset:3072 lds
    s_add_u32 m0, s30, s34
    s_nop 0
    buffer_load_dwordx4 v10, s[8:11], s32 offen offset:0 sc1 lds
    buffer_load_dwordx4 v10, s[8:11], s32 offen offset:1024 sc1 lds
    buffer_load_dwordx4 v10, s[8:11], s32 offen offset:2048 sc1 lds
    buffer_load_dwordx4 v10, s[8:11], s32 offen offset:3072 sc1 lds
    s_add_u32 s32, s32, 57344
    s_cmp_ge_u32 s32, 458752
    s_cselect_b32 s36, 450560, 0
    s_sub_u32 s32, s32, s36
    s_lshl_b32 s33, s32, 3
    s_add_u32 s34, s34, 32768
    s_cmp_eq_u32 s34, 163840
    s_cselect_b32 s34, 0, s34
    s_lshl_b32 s27, s2, 2
    s_add_u32 s27, s27, s20
    s_xor_b32 s26, s27, 16
    s_lshl_b32 s26, s26, 7
    s_add_u32 s26, s26, 33554432
    v_mov_b32 v33, s26
    s_lshl_b32 s27, s27, 13
    s_add_u32 s27, s27, 16777216
    s_add_u32 s60, s78, s27
    s_addc_u32 s61, s79, 0
    s_mov_b32 s35, 3
G2_lloop:
    s_waitcnt vmcnt(24)
    s_barrier
    s_and_b32 s37, s35, 0x17
    s_cmp_eq_u32 s37, 7
    s_cbranch_scc1 G2_chk
G2_lis:
    s_add_u32 m0, s31, s34
    s_nop 0
    buffer_load_dwordx4 v14, s[12:15], s33 offen offset:0 lds
    buffer_load_dwordx4 v15, s[12:15], s33 offen offset:1024 lds
    buffer_load_dwordx4 v16, s[12:15], s33 offen offset:2048 lds
    buffer_load_dwordx4 v17, s[12:15], s33 offen offset:3072 lds
    s_add_u32 m0, s30, s34
    s_nop 0
    buffer_load_dwordx4 v10, s[8:11], s32 offen offset:0 sc1 lds
    buffer_load_dwordx4 v10, s[8:11], s32 offen offset:1024 sc1 lds
    buffer_load_dwordx4 v10, s[8:11], s32 offen offset:2048 sc1 lds
    buffer_load_dwordx4 v10, s[8:11], s32 offen offset:3072 sc1 lds
    s_add_u32 s32, s32, 57344
    s_cmp_ge_u32 s32, 458752
    s_cselect_b32 s36, 450560, 0
    s_sub_u32 s32, s32, s36
    s_lshl_b32 s33, s32, 3
    s_add_u32 s34, s34, 32768
    s_cmp_eq_u32 s34, 163840
    s_cselect_b32 s34, 0, s34
    s_cmp_eq_u32 s37, 3
    s_cbranch_scc0 G2_lnp
    buffer_load_dwordx2 v[12:13], v11, s[44:47], 0 offen sc0 sc1
G2_lnp:
    s_add_u32 s35, s35, 1
    s_cmp_lt_u32 s35, 23
    s_cbranch_scc1 G2_lloop
    s_branch G2_ltail
G2_chk:
    v_cmp_ne_u64 vcc, s[62:63], v[12:13]
    s_cbranch_vccz G2_pc_g
G2_pc_p:
    buffer_load_dwordx2 v[12:13], v11, s[44:47], 0 offen sc0 sc1
    s_waitcnt vmcnt(0)
    v_cmp_ne_u64 vcc, s[62:63], v[12:13]
    s_cbranch_vccz G2_pc_g
    s_sleep 1
    s_sub_u32 s51, s51, 1
    s_cmp_gt_i32 s51, 0
    s_cbranch_scc1 G2_pc_p
G2_pc_g:
    v_add_u32 v11, 128, v11
    s_branch G2_lis
G2_ltail:
    s_getpc_b64 s[48:49]
CT_3:
    s_sub_u32 s48, s48, CT_3-mlp_kernel
    s_subb_u32 s49, s49, 0
    s_lshl_b32 s50, s20, 13
    v_lshlrev_b32 v31, 7, v240
    v_add_u32 v31, s50, v31
    v_min_u32 v31, K_last-mlp_kernel, v31
    global_load_dword v30, v31, s[48:49]
    global_load_dword v34, v33, s[78:79] sc0 sc1
    s_waitcnt vmcnt(26)
    s_barrier
    s_waitcnt vmcnt(18)
    s_barrier
    s_waitcnt vmcnt(10)
    s_barrier
    s_waitcnt vmcnt(2)
    s_barrier
    s_waitcnt vmcnt(2)
    s_barrier
    s_waitcnt vmcnt(0)
K_end:
    s_endpgm
G1_compute:
    s_and_b32 s26, s20, 1
    s_lshr_b32 s27, s20, 1
    v_and_b32 v241, 15, v240
    v_lshrrev_b32 v242, 4, v240
    s_mul_i32 s28, s24, 448
    s_lshl_b32 s29, s27, 8
    s_add_u32 s29, s29, s28
    v_lshlrev_b32 v243, 3, v242
    v_add_u32 v244, s29, v243
    s_lshl_b32 s29, s27, 5
    s_add_u32 s29, s29, s28
    v_add_u32 v245, s29, v243
    s_waitcnt lgkmcnt(0)
    s_mov_b32 s8, s68
    s_and_b32 s9, s69, 0xffff
    s_mov_b32 s10, 7168
    s_mov_b32 s11, 0x20000
    buffer_load_dwordx2 v[156:157], v244, s[8:11], 0 offen offset:0
    buffer_load_dwordx2 v[158:159], v244, s[8:11], 0 offen offset:32
    buffer_load_dwordx2 v[160:161], v244, s[8:11], 0 offen offset:64
    buffer_load_dwordx2 v[162:163], v244, s[8:11], 0 offen offset:96
    buffer_load_dwordx2 v[164:165], v244, s[8:11], 0 offen offset:128
    buffer_load_dwordx2 v[166:167], v244, s[8:11], 0 offen offset:160
    buffer_load_dwordx2 v[168:169], v245, s[8:11], 0 offen offset:192
    s_getpc_b64 s[48:49]
CT_1:
    s_sub_u32 s48, s48, CT_1-mlp_kernel
    s_subb_u32 s49, s49, 0
    s_lshl_b32 s50, s20, 13
    v_lshlrev_b32 v246, 7, v240
    v_add_u32 v246, s50, v246
    v_min_u32 v246, K_last-mlp_kernel, v246
    global_load_dword v210, v246, s[48:49]
    v_lshrrev_b32 v246, 1, v241
    v_xor_b32 v246, v246, v242
    v_lshlrev_b32 v246, 4, v246
    v_lshlrev_b32 v247, 7, v241
    v_add_u32 v246, v246, v247
    s_lshl_b32 s29, s26, 13
    v_add_u32 v200, s29, v246
    v_xor_b32 v201, 64, v200
    v_lshrrev_b32 v246, 2, v241
    v_and_b32 v247, 1, v242
    v_lshlrev_b32 v247, 2, v247
    v_or_b32 v247, v247, v246
    v_lshlrev_b32 v248, 3, v242
    v_add_u32 v248, v248, v246
    v_lshlrev_b32 v248, 9, v248
    v_and_b32 v249, 3, v241
    v_lshlrev_b32 v249, 3, v249
    v_add_u32 v248, v248, v249
    v_add_u32 v248, 16384, v248
    s_and_b32 s29, s24, 1
    s_lshl_b32 s29, s29, 1
    s_lshl_b32 s30, s27, 3
    s_add_u32 s30, s30, s29
    s_add_u32 s31, s29, s27
    s_add_u32 s31, s31, 6
    s_add_u32 s32, s30, 0
    v_xor_b32 v249, s32, v247
    v_lshlrev_b32 v249, 5, v249
    v_add_u32 v202, v248, v249
    s_add_u32 s32, s30, 1
    v_xor_b32 v249, s32, v247
    v_lshlrev_b32 v249, 5, v249
    v_add_u32 v203, v248, v249
    s_add_u32 s32, s30, 2
    v_xor_b32 v249, s32, v247
    v_lshlrev_b32 v249, 5, v249
    v_add_u32 v204, v248, v249
    s_add_u32 s32, s30, 3
    v_xor_b32 v249, s32, v247
    v_lshlrev_b32 v249, 5, v249
    v_add_u32 v205, v248, v249
    s_add_u32 s32, s30, 4
    v_xor_b32 v249, s32, v247
    v_lshlrev_b32 v249, 5, v249
    v_add_u32 v206, v248, v249
    s_add_u32 s32, s30, 5
    v_xor_b32 v249, s32, v247
    v_lshlrev_b32 v249, 5, v249
    v_add_u32 v207, v248, v249
    v_xor_b32 v249, s31, v247
    v_lshlrev_b32 v249, 5, v249
    v_add_u32 v208, v248, v249
    s_waitcnt vmcnt(1)
    v_lshlrev_b32 v212, 16, v156
    v_and_b32 v213, 0xffff0000, v156
    v_lshlrev_b32 v214, 16, v157
    v_and_b32 v215, 0xffff0000, v157
    v_lshlrev_b32 v216, 16, v158
    v_and_b32 v217, 0xffff0000, v158
    v_lshlrev_b32 v218, 16, v159
    v_and_b32 v219, 0xffff0000, v159
    v_lshlrev_b32 v220, 16, v160
    v_and_b32 v221, 0xffff0000, v160
    v_lshlrev_b32 v222, 16, v161
    v_and_b32 v223, 0xffff0000, v161
    v_lshlrev_b32 v224, 16, v162
    v_and_b32 v225, 0xffff0000, v162
    v_lshlrev_b32 v226, 16, v163
    v_and_b32 v227, 0xffff0000, v163
    v_lshlrev_b32 v228, 16, v164
    v_and_b32 v229, 0xffff0000, v164
    v_lshlrev_b32 v230, 16, v165
    v_and_b32 v231, 0xffff0000, v165
    v_lshlrev_b32 v232, 16, v166
    v_and_b32 v233, 0xffff0000, v166
    v_lshlrev_b32 v234, 16, v167
    v_and_b32 v235, 0xffff0000, v167
    v_lshlrev_b32 v236, 16, v168
    v_and_b32 v237, 0xffff0000, v168
    v_lshlrev_b32 v238, 16, v169
    v_and_b32 v239, 0xffff0000, v169
    s_mov_b32 s33, 0
    s_mov_b32 s39, 49152
    s_mov_b32 s35, 0
    s_barrier
    ds_read_b128 v[112:115], v200 offset:0
    ds_read_b128 v[116:119], v200 offset:2048
    ds_read_b128 v[120:123], v200 offset:4096
    ds_read_b128 v[124:127], v200 offset:6144
    ds_read_b64_tr_b16 v[128:129], v202 offset:0
    ds_read_b64_tr_b16 v[130:131], v202 offset:2048
    ds_read_b64_tr_b16 v[132:133], v203 offset:0
    ds_read_b64_tr_b16 v[134:135], v203 offset:2048
    ds_read_b64_tr_b16 v[136:137], v204 offset:0
    ds_read_b64_tr_b16 v[138:139], v204 offset:2048
    ds_read_b64_tr_b16 v[140:141], v205 offset:0
    ds_read_b64_tr_b16 v[142:143], v205 offset:2048
    ds_read_b64_tr_b16 v[144:145], v206 offset:0
    ds_read_b64_tr_b16 v[146:147], v206 offset:2048
    ds_read_b64_tr_b16 v[148:149], v207 offset:0
    ds_read_b64_tr_b16 v[150:151], v207 offset:2048
    ds_read_b64_tr_b16 v[152:153], v208 offset:0
    ds_read_b64_tr_b16 v[154:155], v208 offset:2048
    s_waitcnt lgkmcnt(0)
    v_mfma_f32_16x16x32_bf16 v[0:3], v[128:131], v[112:115], v[212:215]
    ds_read_b128 v[156:159], v201 offset:0
    v_mfma_f32_16x16x32_bf16 v[4:7], v[128:131], v[116:119], v[212:215]
    ds_read_b128 v[160:163], v201 offset:2048
    v_mfma_f32_16x16x32_bf16 v[8:11], v[128:131], v[120:123], v[212:215]
    ds_read_b128 v[164:167], v201 offset:4096
    v_mfma_f32_16x16x32_bf16 v[12:15], v[128:131], v[124:127], v[212:215]
    ds_read_b128 v[168:171], v201 offset:6144
    v_mfma_f32_16x16x32_bf16 v[16:19], v[132:135], v[112:115], v[216:219]
    ds_read_b64_tr_b16 v[172:173], v202 offset:16384
    v_mfma_f32_16x16x32_bf16 v[20:23], v[132:135], v[116:119], v[216:219]
    ds_read_b64_tr_b16 v[174:175], v202 offset:18432
    v_mfma_f32_16x16x32_bf16 v[24:27], v[132:135], v[120:123], v[216:219]
    ds_read_b64_tr_b16 v[176:177], v203 offset:16384
    v_mfma_f32_16x16x32_bf16 v[28:31], v[132:135], v[124:127], v[216:219]
    ds_read_b64_tr_b16 v[178:179], v203 offset:18432
    v_mfma_f32_16x16x32_bf16 v[32:35], v[136:139], v[112:115], v[220:223]
    ds_read_b64_tr_b16 v[180:181], v204 offset:16384
    v_mfma_f32_16x16x32_bf16 v[36:39], v[136:139], v[116:119], v[220:223]
    ds_read_b64_tr_b16 v[182:183], v204 offset:18432
    v_mfma_f32_16x16x32_bf16 v[40:43], v[136:139], v[120:123], v[220:223]
    ds_read_b64_tr_b16 v[184:185], v205 offset:16384
    v_mfma_f32_16x16x32_bf16 v[44:47], v[136:139], v[124:127], v[220:223]
    ds_read_b64_tr_b16 v[186:187], v205 offset:18432
    v_mfma_f32_16x16x32_bf16 v[48:51], v[140:143], v[112:115], v[224:227]
    ds_read_b64_tr_b16 v[188:189], v206 offset:16384
    v_mfma_f32_16x16x32_bf16 v[52:55], v[140:143], v[116:119], v[224:227]
    ds_read_b64_tr_b16 v[190:191], v206 offset:18432
    v_mfma_f32_16x16x32_bf16 v[56:59], v[140:143], v[120:123], v[224:227]
    ds_read_b64_tr_b16 v[192:193], v207 offset:16384
    v_mfma_f32_16x16x32_bf16 v[60:63], v[140:143], v[124:127], v[224:227]
    ds_read_b64_tr_b16 v[194:195], v207 offset:18432
    v_mfma_f32_16x16x32_bf16 v[64:67], v[144:147], v[112:115], v[228:231]
    ds_read_b64_tr_b16 v[196:197], v208 offset:16384
    v_mfma_f32_16x16x32_bf16 v[68:71], v[144:147], v[116:119], v[228:231]
    ds_read_b64_tr_b16 v[198:199], v208 offset:18432
    v_mfma_f32_16x16x32_bf16 v[72:75], v[144:147], v[120:123], v[228:231]
    s_add_u32 s33, s33, 1
    v_mfma_f32_16x16x32_bf16 v[76:79], v[144:147], v[124:127], v[228:231]
    s_cmp_eq_u32 s33, 3
    v_mfma_f32_16x16x32_bf16 v[80:83], v[148:151], v[112:115], v[232:235]
    s_cselect_b32 s34, 4294868992, s39
    v_mfma_f32_16x16x32_bf16 v[84:87], v[148:151], v[116:119], v[232:235]
    s_cselect_b32 s33, 0, s33
    v_mfma_f32_16x16x32_bf16 v[88:91], v[148:151], v[120:123], v[232:235]
    v_add_u32 v200, s34, v200
    v_mfma_f32_16x16x32_bf16 v[92:95], v[148:151], v[124:127], v[232:235]
    v_add_u32 v201, s34, v201
    v_mfma_f32_16x16x32_bf16 v[96:99], v[152:155], v[112:115], v[236:239]
    v_add_u32 v202, s34, v202
    v_mfma_f32_16x16x32_bf16 v[100:103], v[152:155], v[116:119], v[236:239]
    v_add_u32 v203, s34, v203
    v_mfma_f32_16x16x32_bf16 v[104:107], v[152:155], v[120:123], v[236:239]
    v_add_u32 v204, s34, v204
    v_mfma_f32_16x16x32_bf16 v[108:111], v[152:155], v[124:127], v[236:239]
    v_add_u32 v205, s34, v205
    v_add_u32 v206, s34, v206
    v_add_u32 v207, s34, v207
    v_add_u32 v208, s34, v208
    s_waitcnt lgkmcnt(0)
    s_barrier
    v_mfma_f32_16x16x32_bf16 v[0:3], v[172:175], v[156:159], v[0:3]
    ds_read_b128 v[112:115], v200 offset:0
    v_mfma_f32_16x16x32_bf16 v[4:7], v[172:175], v[160:163], v[4:7]
    ds_read_b128 v[116:119], v200 offset:2048
    v_mfma_f32_16x16x32_bf16 v[8:11], v[172:175], v[164:167], v[8:11]
    ds_read_b128 v[120:123], v200 offset:4096
    v_mfma_f32_16x16x32_bf16 v[12:15], v[172:175], v[168:171], v[12:15]
    ds_read_b128 v[124:127], v200 offset:6144
    v_mfma_f32_16x16x32_bf16 v[16:19], v[176:179], v[156:159], v[16:19]
    ds_read_b64_tr_b16 v[128:129], v202 offset:0
    v_mfma_f32_16x16x32_bf16 v[20:23], v[176:179], v[160:163], v[20:23]
    ds_read_b64_tr_b16 v[130:131], v202 offset:2048
    v_mfma_f32_16x16x32_bf16 v[24:27], v[176:179], v[164:167], v[24:27]
    ds_read_b64_tr_b16 v[132:133], v203 offset:0
    v_mfma_f32_16x16x32_bf16 v[28:31], v[176:179], v[168:171], v[28:31]
    ds_read_b64_tr_b16 v[134:135], v203 offset:2048
    v_mfma_f32_16x16x32_bf16 v[32:35], v[180:183], v[156:159], v[32:35]
    ds_read_b64_tr_b16 v[136:137], v204 offset:0
    v_mfma_f32_16x16x32_bf16 v[36:39], v[180:183], v[160:163], v[36:39]
    ds_read_b64_tr_b16 v[138:139], v204 offset:2048
    v_mfma_f32_16x16x32_bf16 v[40:43], v[180:183], v[164:167], v[40:43]
    ds_read_b64_tr_b16 v[140:141], v205 offset:0
    v_mfma_f32_16x16x32_bf16 v[44:47], v[180:183], v[168:171], v[44:47]
    ds_read_b64_tr_b16 v[142:143], v205 offset:2048
    v_mfma_f32_16x16x32_bf16 v[48:51], v[184:187], v[156:159], v[48:51]
    ds_read_b64_tr_b16 v[144:145], v206 offset:0
    v_mfma_f32_16x16x32_bf16 v[52:55], v[184:187], v[160:163], v[52:55]
    ds_read_b64_tr_b16 v[146:147], v206 offset:2048
    v_mfma_f32_16x16x32_bf16 v[56:59], v[184:187], v[164:167], v[56:59]
    ds_read_b64_tr_b16 v[148:149], v207 offset:0
    v_mfma_f32_16x16x32_bf16 v[60:63], v[184:187], v[168:171], v[60:63]
    ds_read_b64_tr_b16 v[150:151], v207 offset:2048
    v_mfma_f32_16x16x32_bf16 v[64:67], v[188:191], v[156:159], v[64:67]
    ds_read_b64_tr_b16 v[152:153], v208 offset:0
    v_mfma_f32_16x16x32_bf16 v[68:71], v[188:191], v[160:163], v[68:71]
    ds_read_b64_tr_b16 v[154:155], v208 offset:2048
    v_mfma_f32_16x16x32_bf16 v[72:75], v[188:191], v[164:167], v[72:75]
    v_mfma_f32_16x16x32_bf16 v[76:79], v[188:191], v[168:171], v[76:79]
    v_mfma_f32_16x16x32_bf16 v[80:83], v[192:195], v[156:159], v[80:83]
    v_mfma_f32_16x16x32_bf16 v[84:87], v[192:195], v[160:163], v[84:87]
    v_mfma_f32_16x16x32_bf16 v[88:91], v[192:195], v[164:167], v[88:91]
    v_mfma_f32_16x16x32_bf16 v[92:95], v[192:195], v[168:171], v[92:95]
    v_mfma_f32_16x16x32_bf16 v[96:99], v[196:199], v[156:159], v[96:99]
    v_mfma_f32_16x16x32_bf16 v[100:103], v[196:199], v[160:163], v[100:103]
    v_mfma_f32_16x16x32_bf16 v[104:107], v[196:199], v[164:167], v[104:107]
    v_mfma_f32_16x16x32_bf16 v[108:111], v[196:199], v[168:171], v[108:111]
    s_waitcnt lgkmcnt(0)
    s_mov_b32 s35, 1
G1_loop:
    v_mfma_f32_16x16x32_bf16 v[0:3], v[128:131], v[112:115], v[0:3]
    ds_read_b128 v[156:159], v201 offset:0
    v_mfma_f32_16x16x32_bf16 v[4:7], v[128:131], v[116:119], v[4:7]
    ds_read_b128 v[160:163], v201 offset:2048
    v_mfma_f32_16x16x32_bf16 v[8:11], v[128:131], v[120:123], v[8:11]
    ds_read_b128 v[164:167], v201 offset:4096
    v_mfma_f32_16x16x32_bf16 v[12:15], v[128:131], v[124:127], v[12:15]
    ds_read_b128 v[168:171], v201 offset:6144
    v_mfma_f32_16x16x32_bf16 v[16:19], v[132:135], v[112:115], v[16:19]
    ds_read_b64_tr_b16 v[172:173], v202 offset:16384
    v_mfma_f32_16x16x32_bf16 v[20:23], v[132:135], v[116:119], v[20:23]
    ds_read_b64_tr_b16 v[174:175], v202 offset:18432
    v_mfma_f32_16x16x32_bf16 v[24:27], v[132:135], v[120:123], v[24:27]
    ds_read_b64_tr_b16 v[176:177], v203 offset:16384
    v_mfma_f32_16x16x32_bf16 v[28:31], v[132:135], v[124:127], v[28:31]
    ds_read_b64_tr_b16 v[178:179], v203 offset:18432
    v_mfma_f32_16x16x32_bf16 v[32:35], v[136:139], v[112:115], v[32:35]
    ds_read_b64_tr_b16 v[180:181], v204 offset:16384
    v_mfma_f32_16x16x32_bf16 v[36:39], v[136:139], v[116:119], v[36:39]
    ds_read_b64_tr_b16 v[182:183], v204 offset:18432
    v_mfma_f32_16x16x32_bf16 v[40:43], v[136:139], v[120:123], v[40:43]
    ds_read_b64_tr_b16 v[184:185], v205 offset:16384
    v_mfma_f32_16x16x32_bf16 v[44:47], v[136:139], v[124:127], v[44:47]
    ds_read_b64_tr_b16 v[186:187], v205 offset:18432
    v_mfma_f32_16x16x32_bf16 v[48:51], v[140:143], v[112:115], v[48:51]
    ds_read_b64_tr_b16 v[188:189], v206 offset:16384
    v_mfma_f32_16x16x32_bf16 v[52:55], v[140:143], v[116:119], v[52:55]
    ds_read_b64_tr_b16 v[190:191], v206 offset:18432
    v_mfma_f32_16x16x32_bf16 v[56:59], v[140:143], v[120:123], v[56:59]
    ds_read_b64_tr_b16 v[192:193], v207 offset:16384
    v_mfma_f32_16x16x32_bf16 v[60:63], v[140:143], v[124:127], v[60:63]
    ds_read_b64_tr_b16 v[194:195], v207 offset:18432
    v_mfma_f32_16x16x32_bf16 v[64:67], v[144:147], v[112:115], v[64:67]
    ds_read_b64_tr_b16 v[196:197], v208 offset:16384
    v_mfma_f32_16x16x32_bf16 v[68:71], v[144:147], v[116:119], v[68:71]
    ds_read_b64_tr_b16 v[198:199], v208 offset:18432
    v_mfma_f32_16x16x32_bf16 v[72:75], v[144:147], v[120:123], v[72:75]
    s_add_u32 s33, s33, 1
    v_mfma_f32_16x16x32_bf16 v[76:79], v[144:147], v[124:127], v[76:79]
    s_cmp_eq_u32 s33, 3
    v_mfma_f32_16x16x32_bf16 v[80:83], v[148:151], v[112:115], v[80:83]
    s_cselect_b32 s34, 4294868992, s39
    v_mfma_f32_16x16x32_bf16 v[84:87], v[148:151], v[116:119], v[84:87]
    s_cselect_b32 s33, 0, s33
    v_mfma_f32_16x16x32_bf16 v[88:91], v[148:151], v[120:123], v[88:91]
    v_add_u32 v200, s34, v200
    v_mfma_f32_16x16x32_bf16 v[92:95], v[148:151], v[124:127], v[92:95]
    v_add_u32 v201, s34, v201
    v_mfma_f32_16x16x32_bf16 v[96:99], v[152:155], v[112:115], v[96:99]
    v_add_u32 v202, s34, v202
    v_mfma_f32_16x16x32_bf16 v[100:103], v[152:155], v[116:119], v[100:103]
    v_add_u32 v203, s34, v203
    v_mfma_f32_16x16x32_bf16 v[104:107], v[152:155], v[120:123], v[104:107]
    v_add_u32 v204, s34, v204
    v_mfma_f32_16x16x32_bf16 v[108:111], v[152:155], v[124:127], v[108:111]
    v_add_u32 v205, s34, v205
    v_add_u32 v206, s34, v206
    v_add_u32 v207, s34, v207
    v_add_u32 v208, s34, v208
    s_waitcnt lgkmcnt(0)
    s_barrier
    s_add_u32 s35, s35, 1
    s_cmp_eq_u32 s35, 16
    s_cbranch_scc1 G1_tail
G1_h2:
    v_mfma_f32_16x16x32_bf16 v[0:3], v[172:175], v[156:159], v[0:3]
    ds_read_b128 v[112:115], v200 offset:0
    v_mfma_f32_16x16x32_bf16 v[4:7], v[172:175], v[160:163], v[4:7]
    ds_read_b128 v[116:119], v200 offset:2048
    v_mfma_f32_16x16x32_bf16 v[8:11], v[172:175], v[164:167], v[8:11]
    ds_read_b128 v[120:123], v200 offset:4096
    v_mfma_f32_16x16x32_bf16 v[12:15], v[172:175], v[168:171], v[12:15]
    ds_read_b128 v[124:127], v200 offset:6144
    v_mfma_f32_16x16x32_bf16 v[16:19], v[176:179], v[156:159], v[16:19]
    ds_read_b64_tr_b16 v[128:129], v202 offset:0
    v_mfma_f32_16x16x32_bf16 v[20:23], v[176:179], v[160:163], v[20:23]
    ds_read_b64_tr_b16 v[130:131], v202 offset:2048
    v_mfma_f32_16x16x32_bf16 v[24:27], v[176:179], v[164:167], v[24:27]
    ds_read_b64_tr_b16 v[132:133], v203 offset:0
    v_mfma_f32_16x16x32_bf16 v[28:31], v[176:179], v[168:171], v[28:31]
    ds_read_b64_tr_b16 v[134:135], v203 offset:2048
    v_mfma_f32_16x16x32_bf16 v[32:35], v[180:183], v[156:159], v[32:35]
    ds_read_b64_tr_b16 v[136:137], v204 offset:0
    v_mfma_f32_16x16x32_bf16 v[36:39], v[180:183], v[160:163], v[36:39]
    ds_read_b64_tr_b16 v[138:139], v204 offset:2048
    v_mfma_f32_16x16x32_bf16 v[40:43], v[180:183], v[164:167], v[40:43]
    ds_read_b64_tr_b16 v[140:141], v205 offset:0
    v_mfma_f32_16x16x32_bf16 v[44:47], v[180:183], v[168:171], v[44:47]
    ds_read_b64_tr_b16 v[142:143], v205 offset:2048
    v_mfma_f32_16x16x32_bf16 v[48:51], v[184:187], v[156:159], v[48:51]
    ds_read_b64_tr_b16 v[144:145], v206 offset:0
    v_mfma_f32_16x16x32_bf16 v[52:55], v[184:187], v[160:163], v[52:55]
    ds_read_b64_tr_b16 v[146:147], v206 offset:2048
    v_mfma_f32_16x16x32_bf16 v[56:59], v[184:187], v[164:167], v[56:59]
    ds_read_b64_tr_b16 v[148:149], v207 offset:0
    v_mfma_f32_16x16x32_bf16 v[60:63], v[184:187], v[168:171], v[60:63]
    ds_read_b64_tr_b16 v[150:151], v207 offset:2048
    v_mfma_f32_16x16x32_bf16 v[64:67], v[188:191], v[156:159], v[64:67]
    ds_read_b64_tr_b16 v[152:153], v208 offset:0
    v_mfma_f32_16x16x32_bf16 v[68:71], v[188:191], v[160:163], v[68:71]
    ds_read_b64_tr_b16 v[154:155], v208 offset:2048
    v_mfma_f32_16x16x32_bf16 v[72:75], v[188:191], v[164:167], v[72:75]
    v_mfma_f32_16x16x32_bf16 v[76:79], v[188:191], v[168:171], v[76:79]
    v_mfma_f32_16x16x32_bf16 v[80:83], v[192:195], v[156:159], v[80:83]
    v_mfma_f32_16x16x32_bf16 v[84:87], v[192:195], v[160:163], v[84:87]
    v_mfma_f32_16x16x32_bf16 v[88:91], v[192:195], v[164:167], v[88:91]
    v_mfma_f32_16x16x32_bf16 v[92:95], v[192:195], v[168:171], v[92:95]
    v_mfma_f32_16x16x32_bf16 v[96:99], v[196:199], v[156:159], v[96:99]
    v_mfma_f32_16x16x32_bf16 v[100:103], v[196:199], v[160:163], v[100:103]
    v_mfma_f32_16x16x32_bf16 v[104:107], v[196:199], v[164:167], v[104:107]
    v_mfma_f32_16x16x32_bf16 v[108:111], v[196:199], v[168:171], v[108:111]
    s_waitcnt lgkmcnt(0)
    s_branch G1_loop
G1_tail:
    v_mfma_f32_16x16x32_bf16 v[0:3], v[172:175], v[156:159], v[0:3]
    v_mfma_f32_16x16x32_bf16 v[4:7], v[172:175], v[160:163], v[4:7]
    v_mfma_f32_16x16x32_bf16 v[8:11], v[172:175], v[164:167], v[8:11]
    v_mfma_f32_16x16x32_bf16 v[12:15], v[172:175], v[168:171], v[12:15]
    v_mfma_f32_16x16x32_bf16 v[16:19], v[176:179], v[156:159], v[16:19]
    v_mfma_f32_16x16x32_bf16 v[20:23], v[176:179], v[160:163], v[20:23]
    v_mfma_f32_16x16x32_bf16 v[24:27], v[176:179], v[164:167], v[24:27]
    v_mfma_f32_16x16x32_bf16 v[28:31], v[176:179], v[168:171], v[28:31]
    v_mfma_f32_16x16x32_bf16 v[32:35], v[180:183], v[156:159], v[32:35]
    v_mfma_f32_16x16x32_bf16 v[36:39], v[180:183], v[160:163], v[36:39]
    v_mfma_f32_16x16x32_bf16 v[40:43], v[180:183], v[164:167], v[40:43]
    v_mfma_f32_16x16x32_bf16 v[44:47], v[180:183], v[168:171], v[44:47]
    v_mfma_f32_16x16x32_bf16 v[48:51], v[184:187], v[156:159], v[48:51]
    v_mfma_f32_16x16x32_bf16 v[52:55], v[184:187], v[160:163], v[52:55]
    v_mfma_f32_16x16x32_bf16 v[56:59], v[184:187], v[164:167], v[56:59]
    v_mfma_f32_16x16x32_bf16 v[60:63], v[184:187], v[168:171], v[60:63]
    v_mfma_f32_16x16x32_bf16 v[64:67], v[188:191], v[156:159], v[64:67]
    v_mfma_f32_16x16x32_bf16 v[68:71], v[188:191], v[160:163], v[68:71]
    v_mfma_f32_16x16x32_bf16 v[72:75], v[188:191], v[164:167], v[72:75]
    v_mfma_f32_16x16x32_bf16 v[76:79], v[188:191], v[168:171], v[76:79]
    v_mfma_f32_16x16x32_bf16 v[80:83], v[192:195], v[156:159], v[80:83]
    v_mfma_f32_16x16x32_bf16 v[84:87], v[192:195], v[160:163], v[84:87]
    v_mfma_f32_16x16x32_bf16 v[88:91], v[192:195], v[164:167], v[88:91]
    v_mfma_f32_16x16x32_bf16 v[92:95], v[192:195], v[168:171], v[92:95]
    v_mfma_f32_16x16x32_bf16 v[96:99], v[196:199], v[156:159], v[96:99]
    v_mfma_f32_16x16x32_bf16 v[100:103], v[196:199], v[160:163], v[100:103]
    v_mfma_f32_16x16x32_bf16 v[104:107], v[196:199], v[164:167], v[104:107]
    v_mfma_f32_16x16x32_bf16 v[108:111], v[196:199], v[168:171], v[108:111]
    s_mov_b32 s8, s72
    s_and_b32 s9, s73, 0xffff
    s_mov_b32 s10, 2048
    s_mov_b32 s11, 0x20000
    s_lshl_b32 s28, s55, 8
    s_lshl_b32 s29, s27, 7
    s_add_u32 s28, s28, s29
    v_add_u32 v244, s28, v243
    buffer_load_dwordx2 v[212:213], v244, s[8:11], 0 offen offset:0
    buffer_load_dwordx2 v[214:215], v244, s[8:11], 0 offen offset:32
    buffer_load_dwordx2 v[216:217], v244, s[8:11], 0 offen offset:64
    buffer_load_dwordx2 v[218:219], v244, s[8:11], 0 offen offset:96
    s_mov_b32 s44, s76
    s_and_b32 s45, s77, 0xffff
    s_mov_b32 s46, 256
    s_mov_b32 s47, 0x20000
    v_mov_b32 v209, 0
    buffer_load_dwordx2 v[210:211], v209, s[44:47], 0 offen sc0 sc1
    s_mov_b32 s12, s78
    s_and_b32 s13, s79, 0xffff
    s_mov_b32 s14, 16777216
    s_mov_b32 s15, 0x20000
    s_lshl_b32 s28, s23, 7
    s_mul_i32 s29, s24, 7
    s_add_u32 s28, s28, s29
    s_lshl_b32 s29, s27, 2
    s_add_u32 s29, s29, s28
    s_lshl_b32 s29, s29, 13
    s_lshl_b32 s30, s26, 12
    s_add_u32 s29, s29, s30
    s_add_u32 s28, s28, 3
    s_lshl_b32 s28, s28, 13
    s_add_u32 s28, s28, s30
    s_lshl_b32 s31, s27, 9
    s_add_u32 s28, s28, s31
    v_lshrrev_b32 v246, 1, v242
    v_lshlrev_b32 v246, 8, v246
    v_lshlrev_b32 v247, 4, v241
    v_add_u32 v247, v247, v246
    v_and_b32 v246, 1, v242
    v_lshlrev_b32 v246, 3, v246
    v_add_u32 v247, v247, v246
    v_add_u32 v247, s28, v247
    v_lshlrev_b32 v246, 4, v240
    v_add_u32 v246, s29, v246
    s_mov_b32 s36, 0xbdd2d3e8
    v_mov_b32 v248, 0xc0135761
    s_mov_b32 s37, 8192
    s_mov_b32 s38, 16384
    s_nop 7
    s_mov_b32 s40, s36
    s_mov_b32 s41, s36
    s_mov_b32 s42, 1.0
    s_mov_b32 s43, 1.0
    v_mov_b32 v249, 0xc0135761
    s_add_u32 s16, s78, 34603008
    s_addc_u32 s17, s79, 0
    s_and_b32 s17, s17, 0xffff
    s_mov_b32 s18, 524288
    s_mov_b32 s19, 0x20000
    s_lshl_b32 s28, s23, 1
    s_lshr_b32 s29, s24, 3
    s_add_u32 s28, s28, s29
    s_lshl_b32 s28, s28, 1
    s_add_u32 s28, s28, s26
    s_lshl_b32 s28, s28, 9
    s_and_b32 s29, s24, 7
    s_lshl_b32 s29, s29, 1
    s_add_u32 s29, s29, s27
    s_lshl_b32 s29, s29, 3
    s_add_u32 s28, s28, s29
    v_mov_b32 v222, s28
    v_pk_mul_f32 v[112:113], v[96:97], v[96:97]
    v_pk_mul_f32 v[114:115], v[98:99], v[98:99]
    v_pk_mul_f32 v[116:117], v[100:101], v[100:101]
    v_pk_mul_f32 v[118:119], v[102:103], v[102:103]
    v_pk_fma_f32 v[112:113], v[112:113], s[40:41], v[248:249]
    v_pk_fma_f32 v[114:115], v[114:115], s[40:41], v[248:249]
    v_pk_fma_f32 v[116:117], v[116:117], s[40:41], v[248:249]
    v_pk_fma_f32 v[118:119], v[118:119], s[40:41], v[248:249]
    v_pk_mul_f32 v[112:113], v[112:113], v[96:97]
    v_pk_mul_f32 v[114:115], v[114:115], v[98:99]
    v_pk_mul_f32 v[116:117], v[116:117], v[100:101]
    v_pk_mul_f32 v[118:119], v[118:119], v[102:103]
    v_exp_f32 v112, v112
    v_exp_f32 v113, v113
    v_exp_f32 v114, v114
    v_exp_f32 v115, v115
    v_exp_f32 v116, v116
    v_exp_f32 v117, v117
    v_exp_f32 v118, v118
    v_exp_f32 v119, v119
    v_pk_add_f32 v[112:113], v[112:113], s[42:43]
    v_pk_add_f32 v[114:115], v[114:115], s[42:43]
    v_pk_add_f32 v[116:117], v[116:117], s[42:43]
    v_pk_add_f32 v[118:119], v[118:119], s[42:43]
    v_rcp_f32 v112, v112
    v_rcp_f32 v113, v113
    v_rcp_f32 v114, v114
    v_rcp_f32 v115, v115
    v_rcp_f32 v116, v116
    v_rcp_f32 v117, v117
    v_rcp_f32 v118, v118
    v_rcp_f32 v119, v119
    v_pk_mul_f32 v[112:113], v[112:113], v[96:97]
    v_pk_mul_f32 v[114:115], v[114:115], v[98:99]
    v_pk_mul_f32 v[116:117], v[116:117], v[100:101]
    v_pk_mul_f32 v[118:119], v[118:119], v[102:103]
    v_cvt_pk_bf16_f32 v144, v112, v113
    v_cvt_pk_bf16_f32 v145, v114, v115
    v_cvt_pk_bf16_f32 v146, v116, v117
    v_cvt_pk_bf16_f32 v147, v118, v119
    buffer_store_dwordx2 v[144:145], v247, s[12:15], 0 offen offset:0 sc0 sc1
    buffer_store_dwordx2 v[146:147], v247, s[12:15], 0 offen offset:1024 sc0 sc1
    v_pk_mul_f32 v[128:129], v[104:105], v[104:105]
    v_pk_mul_f32 v[130:131], v[106:107], v[106:107]
    v_pk_mul_f32 v[132:133], v[108:109], v[108:109]
    v_pk_mul_f32 v[134:135], v[110:111], v[110:111]
    v_pk_fma_f32 v[128:129], v[128:129], s[40:41], v[248:249]
    v_pk_fma_f32 v[130:131], v[130:131], s[40:41], v[248:249]
    v_pk_fma_f32 v[132:133], v[132:133], s[40:41], v[248:249]
    v_pk_fma_f32 v[134:135], v[134:135], s[40:41], v[248:249]
    v_pk_mul_f32 v[128:129], v[128:129], v[104:105]
    v_pk_mul_f32 v[130:131], v[130:131], v[106:107]
    v_pk_mul_f32 v[132:133], v[132:133], v[108:109]
    v_pk_mul_f32 v[134:135], v[134:135], v[110:111]
    v_exp_f32 v128, v128
    v_exp_f32 v129, v129
    v_exp_f32 v130, v130
    v_exp_f32 v131, v131
    v_exp_f32 v132, v132
    v_exp_f32 v133, v133
    v_exp_f32 v134, v134
    v_exp_f32 v135, v135
    v_pk_add_f32 v[128:129], v[128:129], s[42:43]
    v_pk_add_f32 v[130:131], v[130:131], s[42:43]
    v_pk_add_f32 v[132:133], v[132:133], s[42:43]
    v_pk_add_f32 v[134:135], v[134:135], s[42:43]
    v_rcp_f32 v128, v128
    v_rcp_f32 v129, v129
    v_rcp_f32 v130, v130
    v_rcp_f32 v131, v131
    v_rcp_f32 v132, v132
    v_rcp_f32 v133, v133
    v_rcp_f32 v134, v134
    v_rcp_f32 v135, v135
    v_pk_mul_f32 v[128:129], v[128:129], v[104:105]
    v_pk_mul_f32 v[130:131], v[130:131], v[106:107]
    v_pk_mul_f32 v[132:133], v[132:133], v[108:109]
    v_pk_mul_f32 v[134:135], v[134:135], v[110:111]
    v_cvt_pk_bf16_f32 v148, v128, v129
    v_cvt_pk_bf16_f32 v149, v130, v131
    v_cvt_pk_bf16_f32 v150, v132, v133
    v_cvt_pk_bf16_f32 v151, v134, v135
    buffer_store_dwordx2 v[148:149], v247, s[12:15], 0 offen offset:2048 sc0 sc1
    buffer_store_dwordx2 v[150:151], v247, s[12:15], 0 offen offset:3072 sc0 sc1
    v_pk_mul_f32 v[112:113], v[0:1], v[0:1]
    v_pk_mul_f32 v[114:115], v[2:3], v[2:3]
    v_pk_mul_f32 v[116:117], v[16:17], v[16:17]
    v_pk_mul_f32 v[118:119], v[18:19], v[18:19]
    v_pk_fma_f32 v[112:113], v[112:113], s[40:41], v[248:249]
    v_pk_fma_f32 v[114:115], v[114:115], s[40:41], v[248:249]
    v_pk_fma_f32 v[116:117], v[116:117], s[40:41], v[248:249]
    v_pk_fma_f32 v[118:119], v[118:119], s[40:41], v[248:249]
    v_pk_mul_f32 v[112:113], v[112:113], v[0:1]
    v_pk_mul_f32 v[114:115], v[114:115], v[2:3]
    v_pk_mul_f32 v[116:117], v[116:117], v[16:17]
    v_pk_mul_f32 v[118:119], v[118:119], v[18:19]
    v_exp_f32 v112, v112
    v_exp_f32 v113, v113
    v_exp_f32 v114, v114
    v_exp_f32 v115, v115
    v_exp_f32 v116, v116
    v_exp_f32 v117, v117
    v_exp_f32 v118, v118
    v_exp_f32 v119, v119
    v_pk_add_f32 v[112:113], v[112:113], s[42:43]
    v_pk_add_f32 v[114:115], v[114:115], s[42:43]
    v_pk_add_f32 v[116:117], v[116:117], s[42:43]
    v_pk_add_f32 v[118:119], v[118:119], s[42:43]
    v_rcp_f32 v112, v112
    v_rcp_f32 v113, v113
    v_rcp_f32 v114, v114
    v_rcp_f32 v115, v115
    v_rcp_f32 v116, v116
    v_rcp_f32 v117, v117
    v_rcp_f32 v118, v118
    v_rcp_f32 v119, v119
    v_pk_mul_f32 v[112:113], v[112:113], v[0:1]
    v_pk_mul_f32 v[114:115], v[114:115], v[2:3]
    v_pk_mul_f32 v[116:117], v[116:117], v[16:17]
    v_pk_mul_f32 v[118:119], v[118:119], v[18:19]
    v_cvt_pk_bf16_f32 v152, v112, v113
    v_cvt_pk_bf16_f32 v153, v114, v115
    v_cvt_pk_bf16_f32 v154, v116, v117
    v_cvt_pk_bf16_f32 v155, v118, v119
    buffer_store_dwordx4 v[152:155], v246, s[12:15], 0 offen offset:0 sc0 sc1
    v_pk_mul_f32 v[128:129], v[4:5], v[4:5]
    v_pk_mul_f32 v[130:131], v[6:7], v[6:7]
    v_pk_mul_f32 v[132:133], v[20:21], v[20:21]
    v_pk_mul_f32 v[134:135], v[22:23], v[22:23]
    v_pk_fma_f32 v[128:129], v[128:129], s[40:41], v[248:249]
    v_pk_fma_f32 v[130:131], v[130:131], s[40:41], v[248:249]
    v_pk_fma_f32 v[132:133], v[132:133], s[40:41], v[248:249]
    v_pk_fma_f32 v[134:135], v[134:135], s[40:41], v[248:249]
    v_pk_mul_f32 v[128:129], v[128:129], v[4:5]
    v_pk_mul_f32 v[130:131], v[130:131], v[6:7]
    v_pk_mul_f32 v[132:133], v[132:133], v[20:21]
    v_pk_mul_f32 v[134:135], v[134:135], v[22:23]
    v_exp_f32 v128, v128
    v_exp_f32 v129, v129
    v_exp_f32 v130, v130
    v_exp_f32 v131, v131
    v_exp_f32 v132, v132
    v_exp_f32 v133, v133
    v_exp_f32 v134, v134
    v_exp_f32 v135, v135
    v_pk_add_f32 v[128:129], v[128:129], s[42:43]
    v_pk_add_f32 v[130:131], v[130:131], s[42:43]
    v_pk_add_f32 v[132:133], v[132:133], s[42:43]
    v_pk_add_f32 v[134:135], v[134:135], s[42:43]
    v_rcp_f32 v128, v128
    v_rcp_f32 v129, v129
    v_rcp_f32 v130, v130
    v_rcp_f32 v131, v131
    v_rcp_f32 v132, v132
    v_rcp_f32 v133, v133
    v_rcp_f32 v134, v134
    v_rcp_f32 v135, v135
    v_pk_mul_f32 v[128:129], v[128:129], v[4:5]
    v_pk_mul_f32 v[130:131], v[130:131], v[6:7]
    v_pk_mul_f32 v[132:133], v[132:133], v[20:21]
    v_pk_mul_f32 v[134:135], v[134:135], v[22:23]
    v_cvt_pk_bf16_f32 v156, v128, v129
    v_cvt_pk_bf16_f32 v157, v130, v131
    v_cvt_pk_bf16_f32 v158, v132, v133
    v_cvt_pk_bf16_f32 v159, v134, v135
    buffer_store_dwordx4 v[156:159], v246, s[12:15], 0 offen offset:1024 sc0 sc1
    v_pk_mul_f32 v[112:113], v[8:9], v[8:9]
    v_pk_mul_f32 v[114:115], v[10:11], v[10:11]
    v_pk_mul_f32 v[116:117], v[24:25], v[24:25]
    v_pk_mul_f32 v[118:119], v[26:27], v[26:27]
    v_pk_fma_f32 v[112:113], v[112:113], s[40:41], v[248:249]
    v_pk_fma_f32 v[114:115], v[114:115], s[40:41], v[248:249]
    v_pk_fma_f32 v[116:117], v[116:117], s[40:41], v[248:249]
    v_pk_fma_f32 v[118:119], v[118:119], s[40:41], v[248:249]
    v_pk_mul_f32 v[112:113], v[112:113], v[8:9]
    v_pk_mul_f32 v[114:115], v[114:115], v[10:11]
    v_pk_mul_f32 v[116:117], v[116:117], v[24:25]
    v_pk_mul_f32 v[118:119], v[118:119], v[26:27]
    v_exp_f32 v112, v112
    v_exp_f32 v113, v113
    v_exp_f32 v114, v114
    v_exp_f32 v115, v115
    v_exp_f32 v116, v116
    v_exp_f32 v117, v117
    v_exp_f32 v118, v118
    v_exp_f32 v119, v119
    v_pk_add_f32 v[112:113], v[112:113], s[42:43]
    v_pk_add_f32 v[114:115], v[114:115], s[42:43]
    v_pk_add_f32 v[116:117], v[116:117], s[42:43]
    v_pk_add_f32 v[118:119], v[118:119], s[42:43]
    v_rcp_f32 v112, v112
    v_rcp_f32 v113, v113
    v_rcp_f32 v114, v114
    v_rcp_f32 v115, v115
    v_rcp_f32 v116, v116
    v_rcp_f32 v117, v117
    v_rcp_f32 v118, v118
    v_rcp_f32 v119, v119
    v_pk_mul_f32 v[112:113], v[112:113], v[8:9]
    v_pk_mul_f32 v[114:115], v[114:115], v[10:11]
    v_pk_mul_f32 v[116:117], v[116:117], v[24:25]
    v_pk_mul_f32 v[118:119], v[118:119], v[26:27]
    v_cvt_pk_bf16_f32 v160, v112, v113
    v_cvt_pk_bf16_f32 v161, v114, v115
    v_cvt_pk_bf16_f32 v162, v116, v117
    v_cvt_pk_bf16_f32 v163, v118, v119
    buffer_store_dwordx4 v[160:163], v246, s[12:15], 0 offen offset:2048 sc0 sc1
    v_pk_mul_f32 v[128:129], v[12:13], v[12:13]
    v_pk_mul_f32 v[130:131], v[14:15], v[14:15]
    v_pk_mul_f32 v[132:133], v[28:29], v[28:29]
    v_pk_mul_f32 v[134:135], v[30:31], v[30:31]
    v_pk_fma_f32 v[128:129], v[128:129], s[40:41], v[248:249]
    v_pk_fma_f32 v[130:131], v[130:131], s[40:41], v[248:249]
    v_pk_fma_f32 v[132:133], v[132:133], s[40:41], v[248:249]
    v_pk_fma_f32 v[134:135], v[134:135], s[40:41], v[248:249]
    v_pk_mul_f32 v[128:129], v[128:129], v[12:13]
    v_pk_mul_f32 v[130:131], v[130:131], v[14:15]
    v_pk_mul_f32 v[132:133], v[132:133], v[28:29]
    v_pk_mul_f32 v[134:135], v[134:135], v[30:31]
    v_exp_f32 v128, v128
    v_exp_f32 v129, v129
    v_exp_f32 v130, v130
    v_exp_f32 v131, v131
    v_exp_f32 v132, v132
    v_exp_f32 v133, v133
    v_exp_f32 v134, v134
    v_exp_f32 v135, v135
    v_pk_add_f32 v[128:129], v[128:129], s[42:43]
    v_pk_add_f32 v[130:131], v[130:131], s[42:43]
    v_pk_add_f32 v[132:133], v[132:133], s[42:43]
    v_pk_add_f32 v[134:135], v[134:135], s[42:43]
    v_rcp_f32 v128, v128
    v_rcp_f32 v129, v129
    v_rcp_f32 v130, v130
    v_rcp_f32 v131, v131
    v_rcp_f32 v132, v132
    v_rcp_f32 v133, v133
    v_rcp_f32 v134, v134
    v_rcp_f32 v135, v135
    v_pk_mul_f32 v[128:129], v[128:129], v[12:13]
    v_pk_mul_f32 v[130:131], v[130:131], v[14:15]
    v_pk_mul_f32 v[132:133], v[132:133], v[28:29]
    v_pk_mul_f32 v[134:135], v[134:135], v[30:31]
    v_cvt_pk_bf16_f32 v164, v128, v129
    v_cvt_pk_bf16_f32 v165, v130, v131
    v_cvt_pk_bf16_f32 v166, v132, v133
    v_cvt_pk_bf16_f32 v167, v134, v135
    buffer_store_dwordx4 v[164:167], v246, s[12:15], 0 offen offset:3072 sc0 sc1
    s_waitcnt vmcnt(4)
    s_mov_b32 s51, 0x40000
G1_tagw:
    v_readfirstlane_b32 s62, v210
    v_readfirstlane_b32 s63, v211
    s_cmp_lg_u32 s62, 0
    s_cbranch_scc1 G1_tagok
    buffer_load_dwordx2 v[210:211], v209, s[44:47], 0 offen sc0 sc1
    s_sub_u32 s51, s51, 1
    s_waitcnt vmcnt(0)
    s_cmp_lg_u32 s51, 0
    s_cbranch_scc1 G1_tagw
G1_tagok:
    s_mov_b64 exec, 1
    buffer_store_dwordx2 v[210:211], v222, s[16:19], 0 offen offset:0 sc0 sc1
    s_mov_b64 exec, -1
    v_pk_mul_f32 v[112:113], v[32:33], v[32:33]
    v_pk_mul_f32 v[114:115], v[34:35], v[34:35]
    v_pk_mul_f32 v[116:117], v[48:49], v[48:49]
    v_pk_mul_f32 v[118:119], v[50:51], v[50:51]
    v_pk_fma_f32 v[112:113], v[112:113], s[40:41], v[248:249]
    v_pk_fma_f32 v[114:115], v[114:115], s[40:41], v[248:249]
    v_pk_fma_f32 v[116:117], v[116:117], s[40:41], v[248:249]
    v_pk_fma_f32 v[118:119], v[118:119], s[40:41], v[248:249]
    v_pk_mul_f32 v[112:113], v[112:113], v[32:33]
    v_pk_mul_f32 v[114:115], v[114:115], v[34:35]
    v_pk_mul_f32 v[116:117], v[116:117], v[48:49]
    v_pk_mul_f32 v[118:119], v[118:119], v[50:51]
    v_exp_f32 v112, v112
    v_exp_f32 v113, v113
    v_exp_f32 v114, v114
    v_exp_f32 v115, v115
    v_exp_f32 v116, v116
    v_exp_f32 v117, v117
    v_exp_f32 v118, v118
    v_exp_f32 v119, v119
    v_pk_add_f32 v[112:113], v[112:113], s[42:43]
    v_pk_add_f32 v[114:115], v[114:115], s[42:43]
    v_pk_add_f32 v[116:117], v[116:117], s[42:43]
    v_pk_add_f32 v[118:119], v[118:119], s[42:43]
    v_rcp_f32 v112, v112
    v_rcp_f32 v113, v113
    v_rcp_f32 v114, v114
    v_rcp_f32 v115, v115
    v_rcp_f32 v116, v116
    v_rcp_f32 v117, v117
    v_rcp_f32 v118, v118
    v_rcp_f32 v119, v119
    v_pk_mul_f32 v[112:113], v[112:113], v[32:33]
    v_pk_mul_f32 v[114:115], v[114:115], v[34:35]
    v_pk_mul_f32 v[116:117], v[116:117], v[48:49]
    v_pk_mul_f32 v[118:119], v[118:119], v[50:51]
    v_cvt_pk_bf16_f32 v168, v112, v113
    v_cvt_pk_bf16_f32 v169, v114, v115
    v_cvt_pk_bf16_f32 v170, v116, v117
    v_cvt_pk_bf16_f32 v171, v118, v119
    buffer_store_dwordx4 v[168:171], v246, s[12:15], s37 offen offset:0 sc0 sc1
    v_pk_mul_f32 v[128:129], v[36:37], v[36:37]
    v_pk_mul_f32 v[130:131], v[38:39], v[38:39]
    v_pk_mul_f32 v[132:133], v[52:53], v[52:53]
    v_pk_mul_f32 v[134:135], v[54:55], v[54:55]
    v_pk_fma_f32 v[128:129], v[128:129], s[40:41], v[248:249]
    v_pk_fma_f32 v[130:131], v[130:131], s[40:41], v[248:249]
    v_pk_fma_f32 v[132:133], v[132:133], s[40:41], v[248:249]
    v_pk_fma_f32 v[134:135], v[134:135], s[40:41], v[248:249]
    v_pk_mul_f32 v[128:129], v[128:129], v[36:37]
    v_pk_mul_f32 v[130:131], v[130:131], v[38:39]
    v_pk_mul_f32 v[132:133], v[132:133], v[52:53]
    v_pk_mul_f32 v[134:135], v[134:135], v[54:55]
    v_exp_f32 v128, v128
    v_exp_f32 v129, v129
    v_exp_f32 v130, v130
    v_exp_f32 v131, v131
    v_exp_f32 v132, v132
    v_exp_f32 v133, v133
    v_exp_f32 v134, v134
    v_exp_f32 v135, v135
    v_pk_add_f32 v[128:129], v[128:129], s[42:43]
    v_pk_add_f32 v[130:131], v[130:131], s[42:43]
    v_pk_add_f32 v[132:133], v[132:133], s[42:43]
    v_pk_add_f32 v[134:135], v[134:135], s[42:43]
    v_rcp_f32 v128, v128
    v_rcp_f32 v129, v129
    v_rcp_f32 v130, v130
    v_rcp_f32 v131, v131
    v_rcp_f32 v132, v132
    v_rcp_f32 v133, v133
    v_rcp_f32 v134, v134
    v_rcp_f32 v135, v135
    v_pk_mul_f32 v[128:129], v[128:129], v[36:37]
    v_pk_mul_f32 v[130:131], v[130:131], v[38:39]
    v_pk_mul_f32 v[132:133], v[132:133], v[52:53]
    v_pk_mul_f32 v[134:135], v[134:135], v[54:55]
    v_cvt_pk_bf16_f32 v172, v128, v129
    v_cvt_pk_bf16_f32 v173, v130, v131
    v_cvt_pk_bf16_f32 v174, v132, v133
    v_cvt_pk_bf16_f32 v175, v134, v135
    buffer_store_dwordx4 v[172:175], v246, s[12:15], s37 offen offset:1024 sc0 sc1
    v_pk_mul_f32 v[112:113], v[40:41], v[40:41]
    v_pk_mul_f32 v[114:115], v[42:43], v[42:43]
    v_pk_mul_f32 v[116:117], v[56:57], v[56:57]
    v_pk_mul_f32 v[118:119], v[58:59], v[58:59]
    v_pk_fma_f32 v[112:113], v[112:113], s[40:41], v[248:249]
    v_pk_fma_f32 v[114:115], v[114:115], s[40:41], v[248:249]
    v_pk_fma_f32 v[116:117], v[116:117], s[40:41], v[248:249]
    v_pk_fma_f32 v[118:119], v[118:119], s[40:41], v[248:249]
    v_pk_mul_f32 v[112:113], v[112:113], v[40:41]
    v_pk_mul_f32 v[114:115], v[114:115], v[42:43]
    v_pk_mul_f32 v[116:117], v[116:117], v[56:57]
    v_pk_mul_f32 v[118:119], v[118:119], v[58:59]
    v_exp_f32 v112, v112
    v_exp_f32 v113, v113
    v_exp_f32 v114, v114
    v_exp_f32 v115, v115
    v_exp_f32 v116, v116
    v_exp_f32 v117, v117
    v_exp_f32 v118, v118
    v_exp_f32 v119, v119
    v_pk_add_f32 v[112:113], v[112:113], s[42:43]
    v_pk_add_f32 v[114:115], v[114:115], s[42:43]
    v_pk_add_f32 v[116:117], v[116:117], s[42:43]
    v_pk_add_f32 v[118:119], v[118:119], s[42:43]
    v_rcp_f32 v112, v112
    v_rcp_f32 v113, v113
    v_rcp_f32 v114, v114
    v_rcp_f32 v115, v115
    v_rcp_f32 v116, v116
    v_rcp_f32 v117, v117
    v_rcp_f32 v118, v118
    v_rcp_f32 v119, v119
    v_pk_mul_f32 v[112:113], v[112:113], v[40:41]
    v_pk_mul_f32 v[114:115], v[114:115], v[42:43]
    v_pk_mul_f32 v[116:117], v[116:117], v[56:57]
    v_pk_mul_f32 v[118:119], v[118:119], v[58:59]
    v_cvt_pk_bf16_f32 v144, v112, v113
    v_cvt_pk_bf16_f32 v145, v114, v115
    v_cvt_pk_bf16_f32 v146, v116, v117
    v_cvt_pk_bf16_f32 v147, v118, v119
    buffer_store_dwordx4 v[144:147], v246, s[12:15], s37 offen offset:2048 sc0 sc1
    v_pk_mul_f32 v[128:129], v[44:45], v[44:45]
    v_pk_mul_f32 v[130:131], v[46:47], v[46:47]
    v_pk_mul_f32 v[132:133], v[60:61], v[60:61]
    v_pk_mul_f32 v[134:135], v[62:63], v[62:63]
    v_pk_fma_f32 v[128:129], v[128:129], s[40:41], v[248:249]
    v_pk_fma_f32 v[130:131], v[130:131], s[40:41], v[248:249]
    v_pk_fma_f32 v[132:133], v[132:133], s[40:41], v[248:249]
    v_pk_fma_f32 v[134:135], v[134:135], s[40:41], v[248:249]
    v_pk_mul_f32 v[128:129], v[128:129], v[44:45]
    v_pk_mul_f32 v[130:131], v[130:131], v[46:47]
    v_pk_mul_f32 v[132:133], v[132:133], v[60:61]
    v_pk_mul_f32 v[134:135], v[134:135], v[62:63]
    v_exp_f32 v128, v128
    v_exp_f32 v129, v129
    v_exp_f32 v130, v130
    v_exp_f32 v131, v131
    v_exp_f32 v132, v132
    v_exp_f32 v133, v133
    v_exp_f32 v134, v134
    v_exp_f32 v135, v135
    v_pk_add_f32 v[128:129], v[128:129], s[42:43]
    v_pk_add_f32 v[130:131], v[130:131], s[42:43]
    v_pk_add_f32 v[132:133], v[132:133], s[42:43]
    v_pk_add_f32 v[134:135], v[134:135], s[42:43]
    v_rcp_f32 v128, v128
    v_rcp_f32 v129, v129
    v_rcp_f32 v130, v130
    v_rcp_f32 v131, v131
    v_rcp_f32 v132, v132
    v_rcp_f32 v133, v133
    v_rcp_f32 v134, v134
    v_rcp_f32 v135, v135
    v_pk_mul_f32 v[128:129], v[128:129], v[44:45]
    v_pk_mul_f32 v[130:131], v[130:131], v[46:47]
    v_pk_mul_f32 v[132:133], v[132:133], v[60:61]
    v_pk_mul_f32 v[134:135], v[134:135], v[62:63]
    v_cvt_pk_bf16_f32 v148, v128, v129
    v_cvt_pk_bf16_f32 v149, v130, v131
    v_cvt_pk_bf16_f32 v150, v132, v133
    v_cvt_pk_bf16_f32 v151, v134, v135
    buffer_store_dwordx4 v[148:151], v246, s[12:15], s37 offen offset:3072 sc0 sc1
    s_waitcnt vmcnt(5)
    s_mov_b64 exec, 1
    buffer_store_dwordx2 v[210:211], v222, s[16:19], 0 offen offset:128 sc0 sc1
    s_mov_b64 exec, -1
    v_pk_mul_f32 v[112:113], v[64:65], v[64:65]
    v_pk_mul_f32 v[114:115], v[66:67], v[66:67]
    v_pk_mul_f32 v[116:117], v[80:81], v[80:81]
    v_pk_mul_f32 v[118:119], v[82:83], v[82:83]
    v_pk_fma_f32 v[112:113], v[112:113], s[40:41], v[248:249]
    v_pk_fma_f32 v[114:115], v[114:115], s[40:41], v[248:249]
    v_pk_fma_f32 v[116:117], v[116:117], s[40:41], v[248:249]
    v_pk_fma_f32 v[118:119], v[118:119], s[40:41], v[248:249]
    v_pk_mul_f32 v[112:113], v[112:113], v[64:65]
    v_pk_mul_f32 v[114:115], v[114:115], v[66:67]
    v_pk_mul_f32 v[116:117], v[116:117], v[80:81]
    v_pk_mul_f32 v[118:119], v[118:119], v[82:83]
    v_exp_f32 v112, v112
    v_exp_f32 v113, v113
    v_exp_f32 v114, v114
    v_exp_f32 v115, v115
    v_exp_f32 v116, v116
    v_exp_f32 v117, v117
    v_exp_f32 v118, v118
    v_exp_f32 v119, v119
    v_pk_add_f32 v[112:113], v[112:113], s[42:43]
    v_pk_add_f32 v[114:115], v[114:115], s[42:43]
    v_pk_add_f32 v[116:117], v[116:117], s[42:43]
    v_pk_add_f32 v[118:119], v[118:119], s[42:43]
    v_rcp_f32 v112, v112
    v_rcp_f32 v113, v113
    v_rcp_f32 v114, v114
    v_rcp_f32 v115, v115
    v_rcp_f32 v116, v116
    v_rcp_f32 v117, v117
    v_rcp_f32 v118, v118
    v_rcp_f32 v119, v119
    v_pk_mul_f32 v[112:113], v[112:113], v[64:65]
    v_pk_mul_f32 v[114:115], v[114:115], v[66:67]
    v_pk_mul_f32 v[116:117], v[116:117], v[80:81]
    v_pk_mul_f32 v[118:119], v[118:119], v[82:83]
    v_cvt_pk_bf16_f32 v152, v112, v113
    v_cvt_pk_bf16_f32 v153, v114, v115
    v_cvt_pk_bf16_f32 v154, v116, v117
    v_cvt_pk_bf16_f32 v155, v118, v119
    buffer_store_dwordx4 v[152:155], v246, s[12:15], s38 offen offset:0 sc0 sc1
    v_pk_mul_f32 v[128:129], v[68:69], v[68:69]
    v_pk_mul_f32 v[130:131], v[70:71], v[70:71]
    v_pk_mul_f32 v[132:133], v[84:85], v[84:85]
    v_pk_mul_f32 v[134:135], v[86:87], v[86:87]
    v_pk_fma_f32 v[128:129], v[128:129], s[40:41], v[248:249]
    v_pk_fma_f32 v[130:131], v[130:131], s[40:41], v[248:249]
    v_pk_fma_f32 v[132:133], v[132:133], s[40:41], v[248:249]
    v_pk_fma_f32 v[134:135], v[134:135], s[40:41], v[248:249]
    v_pk_mul_f32 v[128:129], v[128:129], v[68:69]
    v_pk_mul_f32 v[130:131], v[130:131], v[70:71]
    v_pk_mul_f32 v[132:133], v[132:133], v[84:85]
    v_pk_mul_f32 v[134:135], v[134:135], v[86:87]
    v_exp_f32 v128, v128
    v_exp_f32 v129, v129
    v_exp_f32 v130, v130
    v_exp_f32 v131, v131
    v_exp_f32 v132, v132
    v_exp_f32 v133, v133
    v_exp_f32 v134, v134
    v_exp_f32 v135, v135
    v_pk_add_f32 v[128:129], v[128:129], s[42:43]
    v_pk_add_f32 v[130:131], v[130:131], s[42:43]
    v_pk_add_f32 v[132:133], v[132:133], s[42:43]
    v_pk_add_f32 v[134:135], v[134:135], s[42:43]
    v_rcp_f32 v128, v128
    v_rcp_f32 v129, v129
    v_rcp_f32 v130, v130
    v_rcp_f32 v131, v131
    v_rcp_f32 v132, v132
    v_rcp_f32 v133, v133
    v_rcp_f32 v134, v134
    v_rcp_f32 v135, v135
    v_pk_mul_f32 v[128:129], v[128:129], v[68:69]
    v_pk_mul_f32 v[130:131], v[130:131], v[70:71]
    v_pk_mul_f32 v[132:133], v[132:133], v[84:85]
    v_pk_mul_f32 v[134:135], v[134:135], v[86:87]
    v_cvt_pk_bf16_f32 v156, v128, v129
    v_cvt_pk_bf16_f32 v157, v130, v131
    v_cvt_pk_bf16_f32 v158, v132, v133
    v_cvt_pk_bf16_f32 v159, v134, v135
    buffer_store_dwordx4 v[156:159], v246, s[12:15], s38 offen offset:1024 sc0 sc1
    v_pk_mul_f32 v[112:113], v[72:73], v[72:73]
    v_pk_mul_f32 v[114:115], v[74:75], v[74:75]
    v_pk_mul_f32 v[116:117], v[88:89], v[88:89]
    v_pk_mul_f32 v[118:119], v[90:91], v[90:91]
    v_pk_fma_f32 v[112:113], v[112:113], s[40:41], v[248:249]
    v_pk_fma_f32 v[114:115], v[114:115], s[40:41], v[248:249]
    v_pk_fma_f32 v[116:117], v[116:117], s[40:41], v[248:249]
    v_pk_fma_f32 v[118:119], v[118:119], s[40:41], v[248:249]
    v_pk_mul_f32 v[112:113], v[112:113], v[72:73]
    v_pk_mul_f32 v[114:115], v[114:115], v[74:75]
    v_pk_mul_f32 v[116:117], v[116:117], v[88:89]
    v_pk_mul_f32 v[118:119], v[118:119], v[90:91]
    v_exp_f32 v112, v112
    v_exp_f32 v113, v113
    v_exp_f32 v114, v114
    v_exp_f32 v115, v115
    v_exp_f32 v116, v116
    v_exp_f32 v117, v117
    v_exp_f32 v118, v118
    v_exp_f32 v119, v119
    v_pk_add_f32 v[112:113], v[112:113], s[42:43]
    v_pk_add_f32 v[114:115], v[114:115], s[42:43]
    v_pk_add_f32 v[116:117], v[116:117], s[42:43]
    v_pk_add_f32 v[118:119], v[118:119], s[42:43]
    v_rcp_f32 v112, v112
    v_rcp_f32 v113, v113
    v_rcp_f32 v114, v114
    v_rcp_f32 v115, v115
    v_rcp_f32 v116, v116
    v_rcp_f32 v117, v117
    v_rcp_f32 v118, v118
    v_rcp_f32 v119, v119
    v_pk_mul_f32 v[112:113], v[112:113], v[72:73]
    v_pk_mul_f32 v[114:115], v[114:115], v[74:75]
    v_pk_mul_f32 v[116:117], v[116:117], v[88:89]
    v_pk_mul_f32 v[118:119], v[118:119], v[90:91]
    v_cvt_pk_bf16_f32 v160, v112, v113
    v_cvt_pk_bf16_f32 v161, v114, v115
    v_cvt_pk_bf16_f32 v162, v116, v117
    v_cvt_pk_bf16_f32 v163, v118, v119
    buffer_store_dwordx4 v[160:163], v246, s[12:15], s38 offen offset:2048 sc0 sc1
    v_pk_mul_f32 v[128:129], v[76:77], v[76:77]
    v_pk_mul_f32 v[130:131], v[78:79], v[78:79]
    v_pk_mul_f32 v[132:133], v[92:93], v[92:93]
    v_pk_mul_f32 v[134:135], v[94:95], v[94:95]
    v_pk_fma_f32 v[128:129], v[128:129], s[40:41], v[248:249]
    v_pk_fma_f32 v[130:131], v[130:131], s[40:41], v[248:249]
    v_pk_fma_f32 v[132:133], v[132:133], s[40:41], v[248:249]
    v_pk_fma_f32 v[134:135], v[134:135], s[40:41], v[248:249]
    v_pk_mul_f32 v[128:129], v[128:129], v[76:77]
    v_pk_mul_f32 v[130:131], v[130:131], v[78:79]
    v_pk_mul_f32 v[132:133], v[132:133], v[92:93]
    v_pk_mul_f32 v[134:135], v[134:135], v[94:95]
    v_exp_f32 v128, v128
    v_exp_f32 v129, v129
    v_exp_f32 v130, v130
    v_exp_f32 v131, v131
    v_exp_f32 v132, v132
    v_exp_f32 v133, v133
    v_exp_f32 v134, v134
    v_exp_f32 v135, v135
    v_pk_add_f32 v[128:129], v[128:129], s[42:43]
    v_pk_add_f32 v[130:131], v[130:131], s[42:43]
    v_pk_add_f32 v[132:133], v[132:133], s[42:43]
    v_pk_add_f32 v[134:135], v[134:135], s[42:43]
    v_rcp_f32 v128, v128
    v_rcp_f32 v129, v129
    v_rcp_f32 v130, v130
    v_rcp_f32 v131, v131
    v_rcp_f32 v132, v132
    v_rcp_f32 v133, v133
    v_rcp_f32 v134, v134
    v_rcp_f32 v135, v135
    v_pk_mul_f32 v[128:129], v[128:129], v[76:77]
    v_pk_mul_f32 v[130:131], v[130:131], v[78:79]
    v_pk_mul_f32 v[132:133], v[132:133], v[92:93]
    v_pk_mul_f32 v[134:135], v[134:135], v[94:95]
    v_cvt_pk_bf16_f32 v164, v128, v129
    v_cvt_pk_bf16_f32 v165, v130, v131
    v_cvt_pk_bf16_f32 v166, v132, v133
    v_cvt_pk_bf16_f32 v167, v134, v135
    buffer_store_dwordx4 v[164:167], v246, s[12:15], s38 offen offset:3072 sc0 sc1
    s_waitcnt vmcnt(5)
    s_mov_b64 exec, 1
    buffer_store_dwordx2 v[210:211], v222, s[16:19], 0 offen offset:256 sc0 sc1
    s_mov_b64 exec, -1
G2_compute:
    s_mov_b32 s23, s54
    s_mov_b32 s24, s55
    s_mov_b32 s25, s56
    v_lshlrev_b32 v246, 4, v240
    s_lshl_b32 s29, s26, 12
    s_lshl_b32 s30, s25, 11
    s_add_u32 s31, s29, s30
    v_add_u32 v128, s31, v246
    s_sub_u32 s31, s29, s30
    s_add_u32 s31, s31, 2048
    v_add_u32 v129, s31, v246
    v_lshrrev_b32 v246, 2, v241
    v_and_b32 v247, 1, v242
    v_lshlrev_b32 v247, 2, v247
    v_or_b32 v247, v247, v246
    v_lshlrev_b32 v248, 2, v242
    v_add_u32 v248, v248, v246
    v_lshlrev_b32 v248, 8, v248
    v_and_b32 v249, 3, v241
    v_lshlrev_b32 v249, 3, v249
    v_add_u32 v248, v248, v249
    v_add_u32 v248, 16384, v248
    s_lshl_b32 s30, s27, 2
    s_add_u32 s32, s30, 0
    v_xor_b32 v249, s32, v247
    v_lshlrev_b32 v249, 5, v249
    v_add_u32 v130, v248, v249
    s_add_u32 s32, s30, 1
    v_xor_b32 v249, s32, v247
    v_lshlrev_b32 v249, 5, v249
    v_add_u32 v131, v248, v249
    s_add_u32 s32, s30, 2
    v_xor_b32 v249, s32, v247
    v_lshlrev_b32 v249, 5, v249
    v_add_u32 v132, v248, v249
    s_add_u32 s32, s30, 3
    v_xor_b32 v249, s32, v247
    v_lshlrev_b32 v249, 5, v249
    v_add_u32 v133, v248, v249
    v_lshlrev_b32 v136, 16, v212
    v_and_b32 v137, 0xffff0000, v212
    v_lshlrev_b32 v138, 16, v213
    v_and_b32 v139, 0xffff0000, v213
    v_lshlrev_b32 v140, 16, v214
    v_and_b32 v141, 0xffff0000, v214
    v_lshlrev_b32 v142, 16, v215
    v_and_b32 v143, 0xffff0000, v215
    v_lshlrev_b32 v144, 16, v216
    v_and_b32 v145, 0xffff0000, v216
    v_lshlrev_b32 v146, 16, v217
    v_and_b32 v147, 0xffff0000, v217
    v_lshlrev_b32 v148, 16, v218
    v_and_b32 v149, 0xffff0000, v218
    v_lshlrev_b32 v150, 16, v219
    v_and_b32 v151, 0xffff0000, v219
    s_mov_b32 s33, 0
    s_mov_b32 s39, 32768
    s_barrier
    ds_read_b128 v[64:67], v128 offset:0
    ds_read_b128 v[68:71], v128 offset:1024
    ds_read_b128 v[72:75], v129 offset:0
    ds_read_b128 v[76:79], v129 offset:1024
    ds_read_b64_tr_b16 v[80:81], v130 offset:0
    ds_read_b64_tr_b16 v[82:83], v130 offset:4096
    ds_read_b64_tr_b16 v[84:85], v131 offset:0
    ds_read_b64_tr_b16 v[86:87], v131 offset:4096
    ds_read_b64_tr_b16 v[88:89], v132 offset:0
    ds_read_b64_tr_b16 v[90:91], v132 offset:4096
    ds_read_b64_tr_b16 v[92:93], v133 offset:0
    ds_read_b64_tr_b16 v[94:95], v133 offset:4096
    s_waitcnt lgkmcnt(0)
    v_mfma_f32_16x16x32_bf16 v[0:3], v[80:83], v[64:67], v[136:139]
    ds_read_b128 v[96:99], v128 offset:8192
    v_mfma_f32_16x16x32_bf16 v[4:7], v[80:83], v[68:71], v[136:139]
    ds_read_b128 v[100:103], v128 offset:9216
    v_mfma_f32_16x16x32_bf16 v[8:11], v[80:83], v[72:75], 0
    ds_read_b128 v[104:107], v129 offset:8192
    v_mfma_f32_16x16x32_bf16 v[12:15], v[80:83], v[76:79], 0
    ds_read_b128 v[108:111], v129 offset:9216
    v_mfma_f32_16x16x32_bf16 v[16:19], v[84:87], v[64:67], v[140:143]
    ds_read_b64_tr_b16 v[112:113], v130 offset:8192
    v_mfma_f32_16x16x32_bf16 v[20:23], v[84:87], v[68:71], v[140:143]
    ds_read_b64_tr_b16 v[114:115], v130 offset:12288
    v_mfma_f32_16x16x32_bf16 v[24:27], v[84:87], v[72:75], 0
    ds_read_b64_tr_b16 v[116:117], v131 offset:8192
    v_mfma_f32_16x16x32_bf16 v[28:31], v[84:87], v[76:79], 0
    ds_read_b64_tr_b16 v[118:119], v131 offset:12288
    v_mfma_f32_16x16x32_bf16 v[32:35], v[88:91], v[64:67], v[144:147]
    ds_read_b64_tr_b16 v[120:121], v132 offset:8192
    s_add_u32 s33, s33, 1
    v_mfma_f32_16x16x32_bf16 v[36:39], v[88:91], v[68:71], v[144:147]
    ds_read_b64_tr_b16 v[122:123], v132 offset:12288
    s_cmp_eq_u32 s33, 5
    v_mfma_f32_16x16x32_bf16 v[40:43], v[88:91], v[72:75], 0
    ds_read_b64_tr_b16 v[124:125], v133 offset:8192
    s_cselect_b32 s34, 4294836224, s39
    v_mfma_f32_16x16x32_bf16 v[44:47], v[88:91], v[76:79], 0
    ds_read_b64_tr_b16 v[126:127], v133 offset:12288
    s_cselect_b32 s33, 0, s33
    v_mfma_f32_16x16x32_bf16 v[48:51], v[92:95], v[64:67], v[148:151]
    v_add_u32 v128, s34, v128
    v_add_u32 v129, s34, v129
    v_mfma_f32_16x16x32_bf16 v[52:55], v[92:95], v[68:71], v[148:151]
    v_add_u32 v130, s34, v130
    v_add_u32 v131, s34, v131
    v_mfma_f32_16x16x32_bf16 v[56:59], v[92:95], v[72:75], 0
    v_add_u32 v132, s34, v132
    v_add_u32 v133, s34, v133
    v_mfma_f32_16x16x32_bf16 v[60:63], v[92:95], v[76:79], 0
    s_waitcnt lgkmcnt(0)
    s_barrier
    v_mfma_f32_16x16x32_bf16 v[0:3], v[112:115], v[96:99], v[0:3]
    ds_read_b128 v[64:67], v128 offset:0
    v_mfma_f32_16x16x32_bf16 v[4:7], v[112:115], v[100:103], v[4:7]
    ds_read_b128 v[68:71], v128 offset:1024
    v_mfma_f32_16x16x32_bf16 v[8:11], v[112:115], v[104:107], v[8:11]
    ds_read_b128 v[72:75], v129 offset:0
    v_mfma_f32_16x16x32_bf16 v[12:15], v[112:115], v[108:111], v[12:15]
    ds_read_b128 v[76:79], v129 offset:1024
    v_mfma_f32_16x16x32_bf16 v[16:19], v[116:119], v[96:99], v[16:19]
    ds_read_b64_tr_b16 v[80:81], v130 offset:0
    v_mfma_f32_16x16x32_bf16 v[20:23], v[116:119], v[100:103], v[20:23]
    ds_read_b64_tr_b16 v[82:83], v130 offset:4096
    v_mfma_f32_16x16x32_bf16 v[24:27], v[116:119], v[104:107], v[24:27]
    ds_read_b64_tr_b16 v[84:85], v131 offset:0
    v_mfma_f32_16x16x32_bf16 v[28:31], v[116:119], v[108:111], v[28:31]
    ds_read_b64_tr_b16 v[86:87], v131 offset:4096
    v_mfma_f32_16x16x32_bf16 v[32:35], v[120:123], v[96:99], v[32:35]
    ds_read_b64_tr_b16 v[88:89], v132 offset:0
    v_mfma_f32_16x16x32_bf16 v[36:39], v[120:123], v[100:103], v[36:39]
    ds_read_b64_tr_b16 v[90:91], v132 offset:4096
    v_mfma_f32_16x16x32_bf16 v[40:43], v[120:123], v[104:107], v[40:43]
    ds_read_b64_tr_b16 v[92:93], v133 offset:0
    v_mfma_f32_16x16x32_bf16 v[44:47], v[120:123], v[108:111], v[44:47]
    ds_read_b64_tr_b16 v[94:95], v133 offset:4096
    v_mfma_f32_16x16x32_bf16 v[48:51], v[124:127], v[96:99], v[48:51]
    v_mfma_f32_16x16x32_bf16 v[52:55], v[124:127], v[100:103], v[52:55]
    v_mfma_f32_16x16x32_bf16 v[56:59], v[124:127], v[104:107], v[56:59]
    v_mfma_f32_16x16x32_bf16 v[60:63], v[124:127], v[108:111], v[60:63]
    s_waitcnt lgkmcnt(0)
    s_mov_b32 s35, 1
G2_loop:
    v_mfma_f32_16x16x32_bf16 v[0:3], v[80:83], v[64:67], v[0:3]
    ds_read_b128 v[96:99], v128 offset:8192
    v_mfma_f32_16x16x32_bf16 v[4:7], v[80:83], v[68:71], v[4:7]
    ds_read_b128 v[100:103], v128 offset:9216
    v_mfma_f32_16x16x32_bf16 v[8:11], v[80:83], v[72:75], v[8:11]
    ds_read_b128 v[104:107], v129 offset:8192
    v_mfma_f32_16x16x32_bf16 v[12:15], v[80:83], v[76:79], v[12:15]
    ds_read_b128 v[108:111], v129 offset:9216
    v_mfma_f32_16x16x32_bf16 v[16:19], v[84:87], v[64:67], v[16:19]
    ds_read_b64_tr_b16 v[112:113], v130 offset:8192
    v_mfma_f32_16x16x32_bf16 v[20:23], v[84:87], v[68:71], v[20:23]
    ds_read_b64_tr_b16 v[114:115], v130 offset:12288
    v_mfma_f32_16x16x32_bf16 v[24:27], v[84:87], v[72:75], v[24:27]
    ds_read_b64_tr_b16 v[116:117], v131 offset:8192
    v_mfma_f32_16x16x32_bf16 v[28:31], v[84:87], v[76:79], v[28:31]
    ds_read_b64_tr_b16 v[118:119], v131 offset:12288
    v_mfma_f32_16x16x32_bf16 v[32:35], v[88:91], v[64:67], v[32:35]
    ds_read_b64_tr_b16 v[120:121], v132 offset:8192
    s_add_u32 s33, s33, 1
    v_mfma_f32_16x16x32_bf16 v[36:39], v[88:91], v[68:71], v[36:39]
    ds_read_b64_tr_b16 v[122:123], v132 offset:12288
    s_cmp_eq_u32 s33, 5
    v_mfma_f32_16x16x32_bf16 v[40:43], v[88:91], v[72:75], v[40:43]
    ds_read_b64_tr_b16 v[124:125], v133 offset:8192
    s_cselect_b32 s34, 4294836224, s39
    v_mfma_f32_16x16x32_bf16 v[44:47], v[88:91], v[76:79], v[44:47]
    ds_read_b64_tr_b16 v[126:127], v133 offset:12288
    s_cselect_b32 s33, 0, s33
    v_mfma_f32_16x16x32_bf16 v[48:51], v[92:95], v[64:67], v[48:51]
    v_add_u32 v128, s34, v128
    v_add_u32 v129, s34, v129
    v_mfma_f32_16x16x32_bf16 v[52:55], v[92:95], v[68:71], v[52:55]
    v_add_u32 v130, s34, v130
    v_add_u32 v131, s34, v131
    v_mfma_f32_16x16x32_bf16 v[56:59], v[92:95], v[72:75], v[56:59]
    v_add_u32 v132, s34, v132
    v_add_u32 v133, s34, v133
    v_mfma_f32_16x16x32_bf16 v[60:63], v[92:95], v[76:79], v[60:63]
    s_waitcnt lgkmcnt(0)
    s_barrier
    s_add_u32 s35, s35, 1
    s_cmp_eq_u32 s35, 28
    s_cbranch_scc1 G2_tail
    s_cmp_eq_u32 s35, 3
    s_cbranch_scc1 G2_pub
G2_h2:
    v_mfma_f32_16x16x32_bf16 v[0:3], v[112:115], v[96:99], v[0:3]
    ds_read_b128 v[64:67], v128 offset:0
    v_mfma_f32_16x16x32_bf16 v[4:7], v[112:115], v[100:103], v[4:7]
    ds_read_b128 v[68:71], v128 offset:1024
    v_mfma_f32_16x16x32_bf16 v[8:11], v[112:115], v[104:107], v[8:11]
    ds_read_b128 v[72:75], v129 offset:0
    v_mfma_f32_16x16x32_bf16 v[12:15], v[112:115], v[108:111], v[12:15]
    ds_read_b128 v[76:79], v129 offset:1024
    v_mfma_f32_16x16x32_bf16 v[16:19], v[116:119], v[96:99], v[16:19]
    ds_read_b64_tr_b16 v[80:81], v130 offset:0
    v_mfma_f32_16x16x32_bf16 v[20:23], v[116:119], v[100:103], v[20:23]
    ds_read_b64_tr_b16 v[82:83], v130 offset:4096
    v_mfma_f32_16x16x32_bf16 v[24:27], v[116:119], v[104:107], v[24:27]
    ds_read_b64_tr_b16 v[84:85], v131 offset:0
    v_mfma_f32_16x16x32_bf16 v[28:31], v[116:119], v[108:111], v[28:31]
    ds_read_b64_tr_b16 v[86:87], v131 offset:4096
    v_mfma_f32_16x16x32_bf16 v[32:35], v[120:123], v[96:99], v[32:35]
    ds_read_b64_tr_b16 v[88:89], v132 offset:0
    v_mfma_f32_16x16x32_bf16 v[36:39], v[120:123], v[100:103], v[36:39]
    ds_read_b64_tr_b16 v[90:91], v132 offset:4096
    v_mfma_f32_16x16x32_bf16 v[40:43], v[120:123], v[104:107], v[40:43]
    ds_read_b64_tr_b16 v[92:93], v133 offset:0
    v_mfma_f32_16x16x32_bf16 v[44:47], v[120:123], v[108:111], v[44:47]
    ds_read_b64_tr_b16 v[94:95], v133 offset:4096
    v_mfma_f32_16x16x32_bf16 v[48:51], v[124:127], v[96:99], v[48:51]
    v_mfma_f32_16x16x32_bf16 v[52:55], v[124:127], v[100:103], v[52:55]
    v_mfma_f32_16x16x32_bf16 v[56:59], v[124:127], v[104:107], v[56:59]
    v_mfma_f32_16x16x32_bf16 v[60:63], v[124:127], v[108:111], v[60:63]
    s_waitcnt lgkmcnt(0)
    s_branch G2_loop
G2_pub:
    s_waitcnt vmcnt(0)
    s_mov_b64 exec, 1
    buffer_store_dwordx2 v[210:211], v222, s[16:19], 0 offen offset:384 sc0 sc1
    s_mov_b64 exec, -1
    s_branch G2_h2
G2_tail:
    v_mfma_f32_16x16x32_bf16 v[0:3], v[112:115], v[96:99], v[0:3]
    v_mfma_f32_16x16x32_bf16 v[4:7], v[112:115], v[100:103], v[4:7]
    v_mfma_f32_16x16x32_bf16 v[8:11], v[112:115], v[104:107], v[8:11]
    v_mfma_f32_16x16x32_bf16 v[12:15], v[112:115], v[108:111], v[12:15]
    v_mfma_f32_16x16x32_bf16 v[16:19], v[116:119], v[96:99], v[16:19]
    v_mfma_f32_16x16x32_bf16 v[20:23], v[116:119], v[100:103], v[20:23]
    v_mfma_f32_16x16x32_bf16 v[24:27], v[116:119], v[104:107], v[24:27]
    v_mfma_f32_16x16x32_bf16 v[28:31], v[116:119], v[108:111], v[28:31]
    v_mfma_f32_16x16x32_bf16 v[32:35], v[120:123], v[96:99], v[32:35]
    v_mfma_f32_16x16x32_bf16 v[36:39], v[120:123], v[100:103], v[36:39]
    v_mfma_f32_16x16x32_bf16 v[40:43], v[120:123], v[104:107], v[40:43]
    v_mfma_f32_16x16x32_bf16 v[44:47], v[120:123], v[108:111], v[44:47]
    v_mfma_f32_16x16x32_bf16 v[48:51], v[124:127], v[96:99], v[48:51]
    v_mfma_f32_16x16x32_bf16 v[52:55], v[124:127], v[100:103], v[52:55]
    v_mfma_f32_16x16x32_bf16 v[56:59], v[124:127], v[104:107], v[56:59]
    v_mfma_f32_16x16x32_bf16 v[60:63], v[124:127], v[108:111], v[60:63]
    s_add_u32 s12, s78, 16777216
    s_addc_u32 s13, s79, 0
    s_and_b32 s13, s13, 0xffff
    s_mov_b32 s14, 8388608
    s_mov_b32 s15, 0x20000
    s_add_u32 s40, s78, 33554432
    s_addc_u32 s41, s79, 0
    s_and_b32 s41, s41, 0xffff
    s_mov_b32 s42, 131072
    s_mov_b32 s43, 0x20000
    s_mov_b32 s44, s74
    s_and_b32 s45, s75, 0xffff
    s_mov_b32 s46, 4194304
    s_mov_b32 s47, 0x20000
    s_lshl_b32 s28, s2, 2
    s_add_u32 s28, s28, s20
    s_xor_b32 s29, s28, 16
    s_lshl_b32 s30, s28, 13
    s_lshl_b32 s31, s29, 13
    s_add_u32 s36, s30, 4096
    s_add_u32 s37, s31, 4096
    v_lshlrev_b32 v246, 4, v240
    s_lshl_b32 s28, s28, 7
    s_lshl_b32 s29, s29, 7
    v_mov_b32 v247, s28
    v_mov_b32 v248, s29
    s_nop 4
    buffer_store_dwordx4 v[8:11], v246, s[12:15], s30 offen offset:0 sc0 sc1
    buffer_store_dwordx4 v[12:15], v246, s[12:15], s30 offen offset:1024 sc0 sc1
    buffer_store_dwordx4 v[24:27], v246, s[12:15], s30 offen offset:2048 sc0 sc1
    buffer_store_dwordx4 v[28:31], v246, s[12:15], s30 offen offset:3072 sc0 sc1
    buffer_store_dwordx4 v[40:43], v246, s[12:15], s36 offen offset:0 sc0 sc1
    buffer_store_dwordx4 v[44:47], v246, s[12:15], s36 offen offset:1024 sc0 sc1
    buffer_store_dwordx4 v[56:59], v246, s[12:15], s36 offen offset:2048 sc0 sc1
    buffer_store_dwordx4 v[60:63], v246, s[12:15], s36 offen offset:3072 sc0 sc1
    s_waitcnt vmcnt(0)
    s_mov_b64 s[48:49], exec
    s_mov_b64 exec, 1
    buffer_store_dwordx2 v[210:211], v247, s[40:43], 0 offen sc0 sc1
    s_mov_b32 s51, 0x40000
G2_poll:
    buffer_load_dwordx2 v[212:213], v248, s[40:43], 0 offen sc0 sc1
    s_waitcnt vmcnt(0)
    v_readfirstlane_b32 s52, v212
    v_readfirstlane_b32 s53, v213
    s_cmp_eq_u64 s[52:53], s[62:63]
    s_cbranch_scc1 G2_got
    s_sleep 1
    s_sub_u32 s51, s51, 1
    s_cmp_lg_u32 s51, 0
    s_cbranch_scc1 G2_poll
G2_got:
    s_mov_b64 exec, s[48:49]
    buffer_load_dwordx4 v[64:67], v246, s[12:15], s31 offen offset:0 sc0 sc1
    buffer_load_dwordx4 v[68:71], v246, s[12:15], s31 offen offset:1024 sc0 sc1
    buffer_load_dwordx4 v[72:75], v246, s[12:15], s31 offen offset:2048 sc0 sc1
    buffer_load_dwordx4 v[76:79], v246, s[12:15], s31 offen offset:3072 sc0 sc1
    buffer_load_dwordx4 v[80:83], v246, s[12:15], s37 offen offset:0 sc0 sc1
    buffer_load_dwordx4 v[84:87], v246, s[12:15], s37 offen offset:1024 sc0 sc1
    buffer_load_dwordx4 v[88:91], v246, s[12:15], s37 offen offset:2048 sc0 sc1
    buffer_load_dwordx4 v[92:95], v246, s[12:15], s37 offen offset:3072 sc0 sc1
    s_lshl_b32 s28, s23, 7
    s_lshl_b32 s29, s26, 6
    s_add_u32 s28, s28, s29
    s_lshl_b32 s29, s25, 5
    s_add_u32 s28, s28, s29
    v_add_u32 v247, s28, v241
    v_lshlrev_b32 v247, 11, v247
    v_add_u32 v247, v247, v244
    s_mov_b32 s38, 32768
    v_add_u32 v247, v247, v243
    s_waitcnt vmcnt(7)
    v_add_f32 v0, v0, v64
    v_add_f32 v1, v1, v65
    v_add_f32 v2, v2, v66
    v_add_f32 v3, v3, v67
    v_cvt_pk_bf16_f32 v112, v0, v1
    v_cvt_pk_bf16_f32 v113, v2, v3
    s_waitcnt vmcnt(6)
    v_add_f32 v4, v4, v68
    v_add_f32 v5, v5, v69
    v_add_f32 v6, v6, v70
    v_add_f32 v7, v7, v71
    v_cvt_pk_bf16_f32 v116, v4, v5
    v_cvt_pk_bf16_f32 v117, v6, v7
    s_waitcnt vmcnt(5)
    v_add_f32 v16, v16, v72
    v_add_f32 v17, v17, v73
    v_add_f32 v18, v18, v74
    v_add_f32 v19, v19, v75
    v_cvt_pk_bf16_f32 v114, v16, v17
    v_cvt_pk_bf16_f32 v115, v18, v19
    s_nop 1
    v_permlane32_swap_b32 v112, v114
    v_permlane32_swap_b32 v113, v115
    s_nop 1
    v_permlane16_swap_b32 v112, v114
    v_permlane16_swap_b32 v113, v115
    s_nop 1
    buffer_store_dwordx4 v[112:115], v247, s[44:47], 0 offen offset:0
    s_waitcnt vmcnt(5)
    v_add_f32 v20, v20, v76
    v_add_f32 v21, v21, v77
    v_add_f32 v22, v22, v78
    v_add_f32 v23, v23, v79
    v_cvt_pk_bf16_f32 v118, v20, v21
    v_cvt_pk_bf16_f32 v119, v22, v23
    s_nop 1
    v_permlane32_swap_b32 v116, v118
    v_permlane32_swap_b32 v117, v119
    s_nop 1
    v_permlane16_swap_b32 v116, v118
    v_permlane16_swap_b32 v117, v119
    s_nop 1
    buffer_store_dwordx4 v[116:119], v247, s[44:47], s38 offen offset:0
    s_waitcnt vmcnt(5)
    v_add_f32 v32, v32, v80
    v_add_f32 v33, v33, v81
    v_add_f32 v34, v34, v82
    v_add_f32 v35, v35, v83
    v_cvt_pk_bf16_f32 v120, v32, v33
    v_cvt_pk_bf16_f32 v121, v34, v35
    s_waitcnt vmcnt(4)
    v_add_f32 v36, v36, v84
    v_add_f32 v37, v37, v85
    v_add_f32 v38, v38, v86
    v_add_f32 v39, v39, v87
    v_cvt_pk_bf16_f32 v124, v36, v37
    v_cvt_pk_bf16_f32 v125, v38, v39
    s_waitcnt vmcnt(3)
    v_add_f32 v48, v48, v88
    v_add_f32 v49, v49, v89
    v_add_f32 v50, v50, v90
    v_add_f32 v51, v51, v91
    v_cvt_pk_bf16_f32 v122, v48, v49
    v_cvt_pk_bf16_f32 v123, v50, v51
    s_nop 1
    v_permlane32_swap_b32 v120, v122
    v_permlane32_swap_b32 v121, v123
    s_nop 1
    v_permlane16_swap_b32 v120, v122
    v_permlane16_swap_b32 v121, v123
    s_nop 1
    buffer_store_dwordx4 v[120:123], v247, s[44:47], 0 offen offset:64
    s_waitcnt vmcnt(3)
    v_add_f32 v52, v52, v92
    v_add_f32 v53, v53, v93
    v_add_f32 v54, v54, v94
    v_add_f32 v55, v55, v95
    v_cvt_pk_bf16_f32 v126, v52, v53
    v_cvt_pk_bf16_f32 v127, v54, v55
    s_nop 1
    v_permlane32_swap_b32 v124, v126
    v_permlane32_swap_b32 v125, v127
    s_nop 1
    v_permlane16_swap_b32 v124, v126
    v_permlane16_swap_b32 v125, v127
    s_nop 1
    buffer_store_dwordx4 v[124:127], v247, s[44:47], s38 offen offset:64
    s_endpgm
K_last:
    s_endpgm
.section .rodata,"a"
.p2align 6
.amdhsa_kernel mlp_kernel
  .amdhsa_next_free_vgpr 256
  .amdhsa_next_free_sgpr 102
  .amdhsa_accum_offset 256
  .amdhsa_group_segment_fixed_size 0
  .amdhsa_kernarg_size 64
  .amdhsa_user_sgpr_count 2
  .amdhsa_user_sgpr_kernarg_segment_ptr 1
  .amdhsa_system_sgpr_workgroup_id_x 1
.end_amdhsa_kernel
```
